```python
import torch

def _softmax(x, axis=-1):
    return torch.softmax(x, dim=axis)
def _gelu(x):
    return torch.nn.functional.gelu(x, approximate="tanh")
def _silu(x):
    return torch.nn.functional.silu(x)
def _sigmoid(x):
    return torch.sigmoid(x)
def _layernorm(x, axis=-1, eps=1e-5):
    m = x.mean(dim=axis, keepdim=True)
    v = x.var(dim=axis, keepdim=True, unbiased=False)
    return (x - m) / torch.sqrt(v + eps)
def _scatter_add(tgt, idx, src, axis=0):
    return tgt.clone().index_add_(axis, idx, src)
def _segment_sum(src, seg, n):
    out = torch.zeros((n,) + src.shape[1:], dtype=src.dtype)
    return out.index_add_(0, seg, src)
def _pad(x, pw):
    flat = tuple(v for pair in reversed(pw) for v in pair)
    return torch.nn.functional.pad(x, flat)

kernel_name = 'sequential_preLN__softmax_full_mha__swiglu_ffn__prompt'

def setup_inputs():

    _w = (lambda a: (lambda t: t.to(torch.bfloat16) if t.is_floating_point() else t)(torch.as_tensor(a)))
    def _A_setup():
        B, S, D = 1, 2048, 512
        return {
            "x": _w((lambda *s: torch.randn(*s, dtype=torch.bfloat16) * 0.05)(B, S, D)),
            "wqkv": _w((lambda *s: torch.randn(*s, dtype=torch.bfloat16) * 0.05)(D, 3 * D)),
            "wo": _w((lambda *s: torch.randn(*s, dtype=torch.bfloat16) * 0.05)(D, D)),
        }
    _A_in = _A_setup()

    def _B_setup():
        B, S, D, F = 1, 2048, 512, 1792
        return {
            "x": _w((lambda *s: torch.randn(*s, dtype=torch.bfloat16) * 0.05)(B, S, D)),
            "w_gate": _w((lambda *s: torch.randn(*s, dtype=torch.bfloat16) * 0.05)(D, F)),
            "w_up": _w((lambda *s: torch.randn(*s, dtype=torch.bfloat16) * 0.05)(D, F)),
            "w_down": _w((lambda *s: torch.randn(*s, dtype=torch.bfloat16) * 0.05)(F, D)),
        }
    _B_in = _B_setup()

    return {
        "A_x": _A_in["x"],
        "A_wqkv": _A_in["wqkv"],
        "A_wo": _A_in["wo"],
        "B_x": _B_in["x"],
        "B_w_gate": _B_in["w_gate"],
        "B_w_up": _B_in["w_up"],
        "B_w_down": _B_in["w_down"],
    }

def reference(A_x, A_wqkv, A_wo, B_x, B_w_gate, B_w_up, B_w_down):
    def _A_ref(x, wqkv, wo):
        B, S, D = x.shape
        H = 32; Dh = D // H
        qkv = (lambda x, *d: x.permute(*d))((x @ wqkv).reshape(B, S, 3, H, Dh), 2, 0, 3, 1, 4)
        q, k, v = qkv[0], qkv[1], qkv[2]
        scale = Dh ** -0.5
        scores = torch.einsum("bhqd,bhkd->bhqk", q, k) * scale
        p = _softmax(scores, axis=-1)
        o = torch.einsum("bhqk,bhkd->bhqd", p, v)
        return (lambda x, *d: x.permute(*d))(o, 0, 2, 1, 3).reshape(B, S, D) @ wo

    def _B_ref(x, w_gate, w_up, w_down):
        g = _silu(x @ w_gate)
        u = x @ w_up
        return (g * u) @ w_down

    x = A_x
    h = x + _A_ref(_layernorm(x, axis=-1), A_wqkv, A_wo)
    h2 = h + _B_ref(_layernorm(h, axis=-1), B_w_gate, B_w_up, B_w_down)
    return h2
```

```asm
; @launch kernel=k1_qkv_kernel grid=(256,1,1) block=(256,1,1) lds=163840
; @launch kernel=k2_attn_kernel grid=(256,1,1) block=(1024,1,1) lds=163840
; @launch kernel=k4_ffn_kernel grid=(256,1,1) block=(256,1,1) lds=163840
.amdgcn_target "amdgcn-amd-amdhsa--gfx950"
.text
.globl k1_qkv_kernel
.p2align 8
.type k1_qkv_kernel,@function
k1_qkv_kernel:
    s_cmp_ge_u32 s2, 256
    s_cbranch_scc1 L_k1_end
    s_load_dwordx2 s[8:9], s[0:1], 0
    s_load_dwordx2 s[12:13], s[0:1], 8
    s_load_dwordx2 s[16:17], s[0:1], 72
    v_and_b32 v1, 63, v0
    v_lshrrev_b32 v40, 6, v0
    s_and_b32 s21, s2, 6
    s_lshl_b32 s21, s21, 2
    s_lshr_b32 s22, s2, 3
    s_and_b32 s22, s22, 7
    v_readfirstlane_b32 s20, v40
    s_add_u32 s21, s21, s22
    s_and_b32 s22, s2, 1
    s_lshl_b32 s22, s22, 2
    s_lshr_b32 s23, s2, 6
    s_add_u32 s22, s22, s23
    s_lshl_b32 s24, s21, 16
    s_lshl_b32 s25, s20, 14
    s_add_u32 s24, s24, s25
    v_lshrrev_b32 v40, 3, v1
    v_lshlrev_b32 v41, 10, v40
    v_add_u32 v41, s24, v41
    v_and_b32 v42, 7, v1
    v_lshrrev_b32 v43, 4, v1
    v_xor_b32 v44, v42, v43
    v_lshl_add_u32 v2, v44, 4, v41
    v_xor_b32 v44, 4, v44
    v_lshl_add_u32 v3, v44, 4, v41
    v_add_u32 v3, 8192, v3
    s_lshl_b32 s25, s20, 4
    v_add_u32 v40, s25, v40
    v_mul_u32_u24 v40, 3072, v40
    v_and_b32 v43, 1, v43
    v_lshlrev_b32 v43, 2, v43
    v_xor_b32 v42, v42, v43
    v_lshl_add_u32 v40, v42, 4, v40
    s_lshl_b32 s25, s22, 7
    v_add_u32 v4, s25, v40
    s_lshl_b32 s27, s20, 11
    s_mov_b32 s10, 0x200000
    s_mov_b32 s11, 0x00020000
    s_mov_b32 s14, 1572864
    s_mov_b32 s15, 0x00020000
    s_mov_b32 s18, 0x10000000
    s_mov_b32 s19, 0x00020000
    s_lshr_b32 s28, s2, 3
    s_lshr_b32 s29, s2, 6
    s_lshl_b32 s29, s29, 1
    s_add_u32 s28, s28, s29
    s_lshr_b32 s28, s2, 3
    s_lshr_b32 s29, s2, 6
    s_add_u32 s28, s28, s29
    s_lshl_b32 s28, s28, 1
    s_add_u32 s29, s28, 0
    s_and_b32 s29, s29, 7
    s_lshl_b32 s40, s29, 7
    s_mul_i32 s48, s29, 196608
    s_add_u32 s29, s28, 1
    s_and_b32 s29, s29, 7
    s_lshl_b32 s41, s29, 7
    s_mul_i32 s49, s29, 196608
    s_add_u32 s29, s28, 2
    s_and_b32 s29, s29, 7
    s_lshl_b32 s42, s29, 7
    s_mul_i32 s50, s29, 196608
    s_add_u32 s29, s28, 3
    s_and_b32 s29, s29, 7
    s_lshl_b32 s43, s29, 7
    s_mul_i32 s51, s29, 196608
    s_add_u32 s29, s28, 4
    s_and_b32 s29, s29, 7
    s_lshl_b32 s44, s29, 7
    s_mul_i32 s52, s29, 196608
    s_add_u32 s29, s28, 5
    s_and_b32 s29, s29, 7
    s_lshl_b32 s45, s29, 7
    s_mul_i32 s53, s29, 196608
    s_add_u32 s29, s28, 6
    s_and_b32 s29, s29, 7
    s_lshl_b32 s46, s29, 7
    s_mul_i32 s54, s29, 196608
    s_add_u32 s29, s28, 7
    s_and_b32 s29, s29, 7
    s_lshl_b32 s47, s29, 7
    s_mul_i32 s55, s29, 196608
    s_waitcnt lgkmcnt(0)
    s_add_u32 m0, s27, 0
    s_nop 0
    buffer_load_dwordx4 v2, s[8:11], s40 offen lds
    s_add_u32 m0, s27, 8192
    s_add_u32 s28, s48, 0
    buffer_load_dwordx4 v4, s[12:15], s28 offen offset:0 lds
    s_add_u32 m0, s27, 15360
    s_add_u32 s28, s48, 0
    buffer_load_dwordx4 v4, s[12:15], s28 offen offset:1024 lds
    s_add_u32 m0, s27, 22528
    s_add_u32 s28, s48, 0
    buffer_load_dwordx4 v4, s[12:15], s28 offen offset:2048 lds
    s_add_u32 m0, s27, 1024
    s_nop 0
    buffer_load_dwordx4 v3, s[8:11], s40 offen lds
    s_add_u32 m0, s27, 9216
    s_add_u32 s28, s48, 24576
    buffer_load_dwordx4 v4, s[12:15], s28 offen offset:0 lds
    s_add_u32 m0, s27, 16384
    s_add_u32 s28, s48, 24576
    buffer_load_dwordx4 v4, s[12:15], s28 offen offset:1024 lds
    s_add_u32 m0, s27, 23552
    s_add_u32 s28, s48, 24576
    buffer_load_dwordx4 v4, s[12:15], s28 offen offset:2048 lds
    s_add_u32 m0, s27, 32768
    s_nop 0
    buffer_load_dwordx4 v2, s[8:11], s41 offen lds
    s_add_u32 m0, s27, 40960
    s_add_u32 s28, s49, 0
    buffer_load_dwordx4 v4, s[12:15], s28 offen offset:0 lds
    s_add_u32 m0, s27, 48128
    s_add_u32 s28, s49, 0
    buffer_load_dwordx4 v4, s[12:15], s28 offen offset:1024 lds
    s_add_u32 m0, s27, 55296
    s_add_u32 s28, s49, 0
    buffer_load_dwordx4 v4, s[12:15], s28 offen offset:2048 lds
    s_add_u32 m0, s27, 33792
    s_nop 0
    buffer_load_dwordx4 v3, s[8:11], s41 offen lds
    s_add_u32 m0, s27, 41984
    s_add_u32 s28, s49, 24576
    buffer_load_dwordx4 v4, s[12:15], s28 offen offset:0 lds
    s_add_u32 m0, s27, 49152
    s_add_u32 s28, s49, 24576
    buffer_load_dwordx4 v4, s[12:15], s28 offen offset:1024 lds
    s_add_u32 m0, s27, 56320
    s_add_u32 s28, s49, 24576
    buffer_load_dwordx4 v4, s[12:15], s28 offen offset:2048 lds
    s_cmp_ge_u32 s2, 16
    s_cbranch_scc1 L_k1_nopf
    v_lshlrev_b32 v46, 4, v1
    s_getpc_b64 s[60:61]
L_pf2:
    s_add_u32 s60, s60, k1_qkv_kernel-L_pf2
    s_addc_u32 s61, s61, -1
    s_mov_b32 s62, L_code_end-k1_qkv_kernel
    s_mov_b32 s63, 0x00020000
    s_mul_i32 s64, s20, 4096
    buffer_load_dwordx4 v[184:187], v46, s[60:63], s64 offen offset:0
    buffer_load_dwordx4 v[184:187], v46, s[60:63], s64 offen offset:1024
    buffer_load_dwordx4 v[184:187], v46, s[60:63], s64 offen offset:2048
    buffer_load_dwordx4 v[184:187], v46, s[60:63], s64 offen offset:3072
L_k1_nopf:
    s_and_b32 s30, s20, 1
    s_lshr_b32 s31, s20, 1
    v_and_b32 v40, 31, v1
    v_lshrrev_b32 v41, 5, v1
    v_bfe_u32 v42, v40, 1, 3
    v_lshlrev_b32 v43, 7, v40
    s_lshl_b32 s29, s30, 12
    v_add_u32 v43, s29, v43
    v_bfe_u32 v44, v1, 2, 2
    v_lshl_add_u32 v45, v41, 3, v44
    v_lshlrev_b32 v45, 7, v45
    v_lshrrev_b32 v44, 1, v44
    v_xor_b32 v44, s31, v44
    v_lshl_add_u32 v45, v44, 6, v45
    v_and_b32 v44, 3, v1
    v_lshl_add_u32 v45, v44, 3, v45
    v_bfe_u32 v44, v1, 4, 1
    v_lshl_add_u32 v45, v44, 5, v45
    s_xor_b32 s29, s20, 0
    s_lshl_b32 s32, s29, 1
    v_add_u32 v44, s32, v41
    v_xor_b32 v44, v44, v42
    v_lshl_add_u32 v8, v44, 4, v43
    s_lshl_b32 s32, s29, 11
    v_add_u32 v20, s32, v45
    v_add_u32 v12, 0x10000, v8
    v_add_u32 v24, 0x10000, v20
    v_add_u32 v16, 0x20000, v8
    v_add_u32 v28, 0x20000, v20
    s_xor_b32 s29, s20, 1
    s_lshl_b32 s32, s29, 1
    v_add_u32 v44, s32, v41
    v_xor_b32 v44, v44, v42
    v_lshl_add_u32 v9, v44, 4, v43
    s_lshl_b32 s32, s29, 11
    v_add_u32 v21, s32, v45
    v_add_u32 v13, 0x10000, v9
    v_add_u32 v25, 0x10000, v21
    v_add_u32 v17, 0x20000, v9
    v_add_u32 v29, 0x20000, v21
    s_xor_b32 s29, s20, 2
    s_lshl_b32 s32, s29, 1
    v_add_u32 v44, s32, v41
    v_xor_b32 v44, v44, v42
    v_lshl_add_u32 v10, v44, 4, v43
    s_lshl_b32 s32, s29, 11
    v_add_u32 v22, s32, v45
    v_add_u32 v14, 0x10000, v10
    v_add_u32 v26, 0x10000, v22
    v_add_u32 v18, 0x20000, v10
    v_add_u32 v30, 0x20000, v22
    s_xor_b32 s29, s20, 3
    s_lshl_b32 s32, s29, 1
    v_add_u32 v44, s32, v41
    v_xor_b32 v44, v44, v42
    v_lshl_add_u32 v11, v44, 4, v43
    s_lshl_b32 s32, s29, 11
    v_add_u32 v23, s32, v45
    v_add_u32 v15, 0x10000, v11
    v_add_u32 v27, 0x10000, v23
    v_add_u32 v19, 0x20000, v11
    v_add_u32 v31, 0x20000, v23
    v_lshrrev_b32 v40, 4, v1
    v_lshrrev_b32 v42, 2, v1
    v_xor_b32 v40, v40, v42
    v_and_b32 v40, 1, v40
    v_cmp_eq_u32 vcc, 0, v40
    v_mov_b32 v42, 0x3f803f80
    s_nop 0
    v_cndmask_b32 v32, 0, v42, vcc
    v_mov_b32 v33, v32
    v_mov_b32 v34, v32
    v_mov_b32 v35, v32
    v_mov_b32 v36, 0
    v_mov_b32 v37, 0
    v_and_b32 v40, 31, v1
    v_cmp_gt_u32 vcc, 24, v40
    v_mov_b32 v40, 0x3f800000
    v_mov_b32 v42, 0x3f800000
    v_cndmask_b32 v46, v40, v42, vcc
    s_lshl_b32 s26, s20, 12
    s_add_u32 s26, s26, 131072
    v_lshlrev_b32 v40, 2, v1
    v_add_u32 v212, s26, v40
    v_and_b32 v40, 31, v1
    v_lshlrev_b32 v40, 2, v40
    s_xor_b32 s29, s26, 8192
    v_add_u32 v213, s29, v40
    s_xor_b32 s29, s26, 4096
    v_add_u32 v214, s29, v40
    s_lshl_b32 s33, s22, 1
    s_add_u32 s33, s33, s31
    s_lshl_b32 s23, s21, 1
    s_add_u32 s23, s23, s30
    s_lshl_b32 s29, s33, 17
    s_lshl_b32 s32, s23, 10
    s_add_u32 s29, s29, s32
    v_lshlrev_b32 v40, 4, v1
    v_add_u32 v215, s29, v40
    v_bfe_u32 v40, v1, 4, 1
    v_lshlrev_b32 v40, 16, v40
    v_lshrrev_b32 v41, 5, v1
    v_lshl_add_u32 v40, v41, 8, v40
    v_and_b32 v42, 15, v1
    v_lshl_add_u32 v40, v42, 4, v40
    v_add_u32 v216, s29, v40
    v_lshlrev_b32 v40, 4, v41
    v_add_u32 v217, s26, v40
    v_lshlrev_b32 v218, 8, v41
    v_cvt_f32_u32 v40, v41
    v_sub_f32 v219, 1.0, v40
    s_lshl_b32 s33, s33, 9
    s_lshl_b32 s32, s23, 2
    s_add_u32 s33, s33, s32
    s_add_u32 s33, s33, 16515072
    s_mov_b32 s34, 4194304
    s_mov_b32 s35, 2097152
    s_mov_b32 s36, 2162688
    s_mov_b32 s37, 65536
    s_mov_b32 s38, 0x80000000
    s_mov_b32 s39, 0x80000000
    v_mov_b32 v195, 0
    v_mov_b32 v199, 0
    v_mov_b32 v203, 0
    v_mov_b32 v207, 0
    v_cmp_gt_u32 vcc, 32, v1
    s_waitcnt vmcnt(8)
    s_barrier
    ds_read_b64_tr_b16 v[56:57], v20 offset:8192
    ds_read_b64_tr_b16 v[58:59], v20 offset:8704
    ds_read_b128 v[48:51], v8 offset:0
    ds_read_b64_tr_b16 v[60:61], v20 offset:16384
    ds_read_b64_tr_b16 v[62:63], v20 offset:16896
    ds_read_b64_tr_b16 v[64:65], v20 offset:24576
    ds_read_b64_tr_b16 v[66:67], v20 offset:25088
    s_waitcnt lgkmcnt(0)
    v_mfma_f32_32x32x16_bf16 v[80:95], v[56:59], v[48:51], 0
    ds_read_b64_tr_b16 v[68:69], v21 offset:8192
    ds_read_b64_tr_b16 v[70:71], v21 offset:8704
    ds_read_b128 v[52:55], v9 offset:0
    s_add_u32 m0, s27, 65536
    s_nop 0
    buffer_load_dwordx4 v2, s[8:11], s42 offen lds
    v_mfma_f32_32x32x16_bf16 v[96:111], v[60:63], v[48:51], 0
    ds_read_b64_tr_b16 v[72:73], v21 offset:16384
    ds_read_b64_tr_b16 v[74:75], v21 offset:16896
    v_and_b32 v144, 0xffff0000, v48
    v_lshlrev_b32 v145, 16, v48
    v_and_b32 v146, 0xffff0000, v49
    v_lshlrev_b32 v147, 16, v49
    v_mfma_f32_32x32x16_bf16 v[112:127], v[48:51], v[64:67], 0
    ds_read_b64_tr_b16 v[76:77], v21 offset:24576
    ds_read_b64_tr_b16 v[78:79], v21 offset:25088
    v_and_b32 v148, 0xffff0000, v50
    v_lshlrev_b32 v149, 16, v50
    v_and_b32 v150, 0xffff0000, v51
    v_lshlrev_b32 v151, 16, v51
    v_mfma_f32_16x16x32_bf16 v[128:131], v[32:35], v[48:51], 0
    v_fmac_f32 v36, v144, v144
    v_fmac_f32 v37, v145, v145
    v_mfma_f32_16x16x32_bf16 v[132:135], v[32:35], v[56:59], 0
    v_fmac_f32 v36, v146, v146
    v_fmac_f32 v37, v147, v147
    v_mfma_f32_16x16x32_bf16 v[136:139], v[32:35], v[60:63], 0
    v_fmac_f32 v36, v148, v148
    v_fmac_f32 v37, v149, v149
    v_mfma_f32_16x16x32_bf16 v[140:143], v[32:35], v[64:67], 0
    v_fmac_f32 v36, v150, v150
    v_fmac_f32 v37, v151, v151
    s_waitcnt lgkmcnt(0)
    v_mfma_f32_32x32x16_bf16 v[80:95], v[68:71], v[52:55], v[80:95]
    ds_read_b64_tr_b16 v[56:57], v22 offset:8192
    ds_read_b64_tr_b16 v[58:59], v22 offset:8704
    ds_read_b128 v[48:51], v10 offset:0
    s_add_u32 m0, s27, 73728
    s_add_u32 s28, s50, 0
    buffer_load_dwordx4 v4, s[12:15], s28 offen offset:0 lds
    v_mfma_f32_32x32x16_bf16 v[96:111], v[72:75], v[52:55], v[96:111]
    ds_read_b64_tr_b16 v[60:61], v22 offset:16384
    ds_read_b64_tr_b16 v[62:63], v22 offset:16896
    v_and_b32 v144, 0xffff0000, v52
    v_lshlrev_b32 v145, 16, v52
    v_and_b32 v146, 0xffff0000, v53
    v_lshlrev_b32 v147, 16, v53
    v_mfma_f32_32x32x16_bf16 v[112:127], v[52:55], v[76:79], v[112:127]
    ds_read_b64_tr_b16 v[64:65], v22 offset:24576
    ds_read_b64_tr_b16 v[66:67], v22 offset:25088
    v_and_b32 v148, 0xffff0000, v54
    v_lshlrev_b32 v149, 16, v54
    v_and_b32 v150, 0xffff0000, v55
    v_lshlrev_b32 v151, 16, v55
    v_mfma_f32_16x16x32_bf16 v[128:131], v[32:35], v[52:55], v[128:131]
    v_fmac_f32 v36, v144, v144
    v_fmac_f32 v37, v145, v145
    v_fmac_f32 v36, v146, v146
    v_fmac_f32 v37, v147, v147
    v_fmac_f32 v36, v148, v148
    v_fmac_f32 v37, v149, v149
    v_fmac_f32 v36, v150, v150
    v_fmac_f32 v37, v151, v151
    s_waitcnt lgkmcnt(0)
    v_mfma_f32_32x32x16_bf16 v[80:95], v[56:59], v[48:51], v[80:95]
    ds_read_b64_tr_b16 v[68:69], v23 offset:8192
    ds_read_b64_tr_b16 v[70:71], v23 offset:8704
    ds_read_b128 v[52:55], v11 offset:0
    s_add_u32 m0, s27, 80896
    s_add_u32 s28, s50, 0
    buffer_load_dwordx4 v4, s[12:15], s28 offen offset:1024 lds
    v_mfma_f32_32x32x16_bf16 v[96:111], v[60:63], v[48:51], v[96:111]
    ds_read_b64_tr_b16 v[72:73], v23 offset:16384
    ds_read_b64_tr_b16 v[74:75], v23 offset:16896
    s_add_u32 m0, s27, 88064
    s_add_u32 s28, s50, 0
    buffer_load_dwordx4 v4, s[12:15], s28 offen offset:2048 lds
    v_mfma_f32_32x32x16_bf16 v[112:127], v[48:51], v[64:67], v[112:127]
    ds_read_b64_tr_b16 v[76:77], v23 offset:24576
    ds_read_b64_tr_b16 v[78:79], v23 offset:25088
    s_add_u32 m0, s27, 66560
    s_nop 0
    buffer_load_dwordx4 v3, s[8:11], s42 offen lds
    v_mfma_f32_16x16x32_bf16 v[132:135], v[32:35], v[56:59], v[132:135]
    v_mfma_f32_16x16x32_bf16 v[136:139], v[32:35], v[60:63], v[136:139]
    v_mfma_f32_16x16x32_bf16 v[140:143], v[32:35], v[64:67], v[140:143]
    s_waitcnt vmcnt(5)
    s_barrier
    s_waitcnt lgkmcnt(0)
    v_mfma_f32_32x32x16_bf16 v[80:95], v[68:71], v[52:55], v[80:95]
    ds_read_b64_tr_b16 v[56:57], v20 offset:40960
    ds_read_b64_tr_b16 v[58:59], v20 offset:41472
    ds_read_b128 v[48:51], v8 offset:32768
    s_add_u32 m0, s27, 74752
    s_add_u32 s28, s50, 24576
    buffer_load_dwordx4 v4, s[12:15], s28 offen offset:0 lds
    v_mfma_f32_32x32x16_bf16 v[96:111], v[72:75], v[52:55], v[96:111]
    ds_read_b64_tr_b16 v[60:61], v20 offset:49152
    ds_read_b64_tr_b16 v[62:63], v20 offset:49664
    s_add_u32 m0, s27, 81920
    s_add_u32 s28, s50, 24576
    buffer_load_dwordx4 v4, s[12:15], s28 offen offset:1024 lds
    v_mfma_f32_32x32x16_bf16 v[112:127], v[52:55], v[76:79], v[112:127]
    ds_read_b64_tr_b16 v[64:65], v20 offset:57344
    ds_read_b64_tr_b16 v[66:67], v20 offset:57856
    s_add_u32 m0, s27, 89088
    s_add_u32 s28, s50, 24576
    buffer_load_dwordx4 v4, s[12:15], s28 offen offset:2048 lds
    s_waitcnt lgkmcnt(0)
    v_mfma_f32_32x32x16_bf16 v[80:95], v[56:59], v[48:51], v[80:95]
    ds_read_b64_tr_b16 v[68:69], v21 offset:40960
    ds_read_b64_tr_b16 v[70:71], v21 offset:41472
    ds_read_b128 v[52:55], v9 offset:32768
    s_add_u32 m0, s27, 98304
    s_nop 0
    buffer_load_dwordx4 v2, s[8:11], s43 offen lds
    v_mfma_f32_32x32x16_bf16 v[96:111], v[60:63], v[48:51], v[96:111]
    ds_read_b64_tr_b16 v[72:73], v21 offset:49152
    ds_read_b64_tr_b16 v[74:75], v21 offset:49664
    v_and_b32 v144, 0xffff0000, v48
    v_lshlrev_b32 v145, 16, v48
    v_and_b32 v146, 0xffff0000, v49
    v_lshlrev_b32 v147, 16, v49
    v_mfma_f32_32x32x16_bf16 v[112:127], v[48:51], v[64:67], v[112:127]
    ds_read_b64_tr_b16 v[76:77], v21 offset:57344
    ds_read_b64_tr_b16 v[78:79], v21 offset:57856
    v_and_b32 v148, 0xffff0000, v50
    v_lshlrev_b32 v149, 16, v50
    v_and_b32 v150, 0xffff0000, v51
    v_lshlrev_b32 v151, 16, v51
    v_mfma_f32_16x16x32_bf16 v[128:131], v[32:35], v[48:51], v[128:131]
    v_fmac_f32 v36, v144, v144
    v_fmac_f32 v37, v145, v145
    v_mfma_f32_16x16x32_bf16 v[132:135], v[32:35], v[56:59], v[132:135]
    v_fmac_f32 v36, v146, v146
    v_fmac_f32 v37, v147, v147
    v_mfma_f32_16x16x32_bf16 v[136:139], v[32:35], v[60:63], v[136:139]
    v_fmac_f32 v36, v148, v148
    v_fmac_f32 v37, v149, v149
    v_mfma_f32_16x16x32_bf16 v[140:143], v[32:35], v[64:67], v[140:143]
    v_fmac_f32 v36, v150, v150
    v_fmac_f32 v37, v151, v151
    s_waitcnt lgkmcnt(0)
    v_mfma_f32_32x32x16_bf16 v[80:95], v[68:71], v[52:55], v[80:95]
    ds_read_b64_tr_b16 v[56:57], v22 offset:40960
    ds_read_b64_tr_b16 v[58:59], v22 offset:41472
    ds_read_b128 v[48:51], v10 offset:32768
    s_add_u32 m0, s27, 106496
    s_add_u32 s28, s51, 0
    buffer_load_dwordx4 v4, s[12:15], s28 offen offset:0 lds
    v_mfma_f32_32x32x16_bf16 v[96:111], v[72:75], v[52:55], v[96:111]
    ds_read_b64_tr_b16 v[60:61], v22 offset:49152
    ds_read_b64_tr_b16 v[62:63], v22 offset:49664
    v_and_b32 v144, 0xffff0000, v52
    v_lshlrev_b32 v145, 16, v52
    v_and_b32 v146, 0xffff0000, v53
    v_lshlrev_b32 v147, 16, v53
    v_mfma_f32_32x32x16_bf16 v[112:127], v[52:55], v[76:79], v[112:127]
    ds_read_b64_tr_b16 v[64:65], v22 offset:57344
    ds_read_b64_tr_b16 v[66:67], v22 offset:57856
    v_and_b32 v148, 0xffff0000, v54
    v_lshlrev_b32 v149, 16, v54
    v_and_b32 v150, 0xffff0000, v55
    v_lshlrev_b32 v151, 16, v55
    v_mfma_f32_16x16x32_bf16 v[128:131], v[32:35], v[52:55], v[128:131]
    v_fmac_f32 v36, v144, v144
    v_fmac_f32 v37, v145, v145
    v_fmac_f32 v36, v146, v146
    v_fmac_f32 v37, v147, v147
    v_fmac_f32 v36, v148, v148
    v_fmac_f32 v37, v149, v149
    v_fmac_f32 v36, v150, v150
    v_fmac_f32 v37, v151, v151
    s_waitcnt lgkmcnt(0)
    v_mfma_f32_32x32x16_bf16 v[80:95], v[56:59], v[48:51], v[80:95]
    ds_read_b64_tr_b16 v[68:69], v23 offset:40960
    ds_read_b64_tr_b16 v[70:71], v23 offset:41472
    ds_read_b128 v[52:55], v11 offset:32768
    s_add_u32 m0, s27, 113664
    s_add_u32 s28, s51, 0
    buffer_load_dwordx4 v4, s[12:15], s28 offen offset:1024 lds
    v_mfma_f32_32x32x16_bf16 v[96:111], v[60:63], v[48:51], v[96:111]
    ds_read_b64_tr_b16 v[72:73], v23 offset:49152
    ds_read_b64_tr_b16 v[74:75], v23 offset:49664
    s_add_u32 m0, s27, 120832
    s_add_u32 s28, s51, 0
    buffer_load_dwordx4 v4, s[12:15], s28 offen offset:2048 lds
    v_mfma_f32_32x32x16_bf16 v[112:127], v[48:51], v[64:67], v[112:127]
    ds_read_b64_tr_b16 v[76:77], v23 offset:57344
    ds_read_b64_tr_b16 v[78:79], v23 offset:57856
    s_add_u32 m0, s27, 99328
    s_nop 0
    buffer_load_dwordx4 v3, s[8:11], s43 offen lds
    v_mfma_f32_16x16x32_bf16 v[132:135], v[32:35], v[56:59], v[132:135]
    v_mfma_f32_16x16x32_bf16 v[136:139], v[32:35], v[60:63], v[136:139]
    v_mfma_f32_16x16x32_bf16 v[140:143], v[32:35], v[64:67], v[140:143]
    s_waitcnt vmcnt(5)
    s_barrier
    s_waitcnt lgkmcnt(0)
    v_mfma_f32_32x32x16_bf16 v[80:95], v[68:71], v[52:55], v[80:95]
    ds_read_b64_tr_b16 v[56:57], v24 offset:8192
    ds_read_b64_tr_b16 v[58:59], v24 offset:8704
    ds_read_b128 v[48:51], v12 offset:0
    s_add_u32 m0, s27, 107520
    s_add_u32 s28, s51, 24576
    buffer_load_dwordx4 v4, s[12:15], s28 offen offset:0 lds
    v_mfma_f32_32x32x16_bf16 v[96:111], v[72:75], v[52:55], v[96:111]
    ds_read_b64_tr_b16 v[60:61], v24 offset:16384
    ds_read_b64_tr_b16 v[62:63], v24 offset:16896
    s_add_u32 m0, s27, 114688
    s_add_u32 s28, s51, 24576
    buffer_load_dwordx4 v4, s[12:15], s28 offen offset:1024 lds
    v_mfma_f32_32x32x16_bf16 v[112:127], v[52:55], v[76:79], v[112:127]
    ds_read_b64_tr_b16 v[64:65], v24 offset:24576
    ds_read_b64_tr_b16 v[66:67], v24 offset:25088
    s_add_u32 m0, s27, 121856
    s_add_u32 s28, s51, 24576
    buffer_load_dwordx4 v4, s[12:15], s28 offen offset:2048 lds
    s_waitcnt lgkmcnt(0)
    v_mfma_f32_32x32x16_bf16 v[80:95], v[56:59], v[48:51], v[80:95]
    ds_read_b64_tr_b16 v[68:69], v25 offset:8192
    ds_read_b64_tr_b16 v[70:71], v25 offset:8704
    ds_read_b128 v[52:55], v13 offset:0
    s_add_u32 m0, s27, 131072
    s_nop 0
    buffer_load_dwordx4 v2, s[8:11], s44 offen lds
    v_mfma_f32_32x32x16_bf16 v[96:111], v[60:63], v[48:51], v[96:111]
    ds_read_b64_tr_b16 v[72:73], v25 offset:16384
    ds_read_b64_tr_b16 v[74:75], v25 offset:16896
    v_and_b32 v144, 0xffff0000, v48
    v_lshlrev_b32 v145, 16, v48
    v_and_b32 v146, 0xffff0000, v49
    v_lshlrev_b32 v147, 16, v49
    v_mfma_f32_32x32x16_bf16 v[112:127], v[48:51], v[64:67], v[112:127]
    ds_read_b64_tr_b16 v[76:77], v25 offset:24576
    ds_read_b64_tr_b16 v[78:79], v25 offset:25088
    v_and_b32 v148, 0xffff0000, v50
    v_lshlrev_b32 v149, 16, v50
    v_and_b32 v150, 0xffff0000, v51
    v_lshlrev_b32 v151, 16, v51
    v_mfma_f32_16x16x32_bf16 v[128:131], v[32:35], v[48:51], v[128:131]
    v_fmac_f32 v36, v144, v144
    v_fmac_f32 v37, v145, v145
    v_mfma_f32_16x16x32_bf16 v[132:135], v[32:35], v[56:59], v[132:135]
    v_fmac_f32 v36, v146, v146
    v_fmac_f32 v37, v147, v147
    v_mfma_f32_16x16x32_bf16 v[136:139], v[32:35], v[60:63], v[136:139]
    v_fmac_f32 v36, v148, v148
    v_fmac_f32 v37, v149, v149
    v_mfma_f32_16x16x32_bf16 v[140:143], v[32:35], v[64:67], v[140:143]
    v_fmac_f32 v36, v150, v150
    v_fmac_f32 v37, v151, v151
    s_waitcnt lgkmcnt(0)
    v_mfma_f32_32x32x16_bf16 v[80:95], v[68:71], v[52:55], v[80:95]
    ds_read_b64_tr_b16 v[56:57], v26 offset:8192
    ds_read_b64_tr_b16 v[58:59], v26 offset:8704
    ds_read_b128 v[48:51], v14 offset:0
    s_add_u32 m0, s27, 139264
    s_add_u32 s28, s52, 0
    buffer_load_dwordx4 v4, s[12:15], s28 offen offset:0 lds
    v_mfma_f32_32x32x16_bf16 v[96:111], v[72:75], v[52:55], v[96:111]
    ds_read_b64_tr_b16 v[60:61], v26 offset:16384
    ds_read_b64_tr_b16 v[62:63], v26 offset:16896
    v_and_b32 v144, 0xffff0000, v52
    v_lshlrev_b32 v145, 16, v52
    v_and_b32 v146, 0xffff0000, v53
    v_lshlrev_b32 v147, 16, v53
    v_mfma_f32_32x32x16_bf16 v[112:127], v[52:55], v[76:79], v[112:127]
    ds_read_b64_tr_b16 v[64:65], v26 offset:24576
    ds_read_b64_tr_b16 v[66:67], v26 offset:25088
    v_and_b32 v148, 0xffff0000, v54
    v_lshlrev_b32 v149, 16, v54
    v_and_b32 v150, 0xffff0000, v55
    v_lshlrev_b32 v151, 16, v55
    v_mfma_f32_16x16x32_bf16 v[128:131], v[32:35], v[52:55], v[128:131]
    v_fmac_f32 v36, v144, v144
    v_fmac_f32 v37, v145, v145
    v_fmac_f32 v36, v146, v146
    v_fmac_f32 v37, v147, v147
    v_fmac_f32 v36, v148, v148
    v_fmac_f32 v37, v149, v149
    v_fmac_f32 v36, v150, v150
    v_fmac_f32 v37, v151, v151
    s_waitcnt lgkmcnt(0)
    v_mfma_f32_32x32x16_bf16 v[80:95], v[56:59], v[48:51], v[80:95]
    ds_read_b64_tr_b16 v[68:69], v27 offset:8192
    ds_read_b64_tr_b16 v[70:71], v27 offset:8704
    ds_read_b128 v[52:55], v15 offset:0
    s_add_u32 m0, s27, 146432
    s_add_u32 s28, s52, 0
    buffer_load_dwordx4 v4, s[12:15], s28 offen offset:1024 lds
    v_mfma_f32_32x32x16_bf16 v[96:111], v[60:63], v[48:51], v[96:111]
    ds_read_b64_tr_b16 v[72:73], v27 offset:16384
    ds_read_b64_tr_b16 v[74:75], v27 offset:16896
    s_add_u32 m0, s27, 153600
    s_add_u32 s28, s52, 0
    buffer_load_dwordx4 v4, s[12:15], s28 offen offset:2048 lds
    v_mfma_f32_32x32x16_bf16 v[112:127], v[48:51], v[64:67], v[112:127]
    ds_read_b64_tr_b16 v[76:77], v27 offset:24576
    ds_read_b64_tr_b16 v[78:79], v27 offset:25088
    s_add_u32 m0, s27, 132096
    s_nop 0
    buffer_load_dwordx4 v3, s[8:11], s44 offen lds
    v_mfma_f32_16x16x32_bf16 v[132:135], v[32:35], v[56:59], v[132:135]
    v_mfma_f32_16x16x32_bf16 v[136:139], v[32:35], v[60:63], v[136:139]
    v_mfma_f32_16x16x32_bf16 v[140:143], v[32:35], v[64:67], v[140:143]
    s_waitcnt vmcnt(5)
    s_barrier
    s_waitcnt lgkmcnt(0)
    v_mfma_f32_32x32x16_bf16 v[80:95], v[68:71], v[52:55], v[80:95]
    ds_read_b64_tr_b16 v[56:57], v24 offset:40960
    ds_read_b64_tr_b16 v[58:59], v24 offset:41472
    ds_read_b128 v[48:51], v12 offset:32768
    s_add_u32 m0, s27, 140288
    s_add_u32 s28, s52, 24576
    buffer_load_dwordx4 v4, s[12:15], s28 offen offset:0 lds
    v_mfma_f32_32x32x16_bf16 v[96:111], v[72:75], v[52:55], v[96:111]
    ds_read_b64_tr_b16 v[60:61], v24 offset:49152
    ds_read_b64_tr_b16 v[62:63], v24 offset:49664
    s_add_u32 m0, s27, 147456
    s_add_u32 s28, s52, 24576
    buffer_load_dwordx4 v4, s[12:15], s28 offen offset:1024 lds
    v_mfma_f32_32x32x16_bf16 v[112:127], v[52:55], v[76:79], v[112:127]
    ds_read_b64_tr_b16 v[64:65], v24 offset:57344
    ds_read_b64_tr_b16 v[66:67], v24 offset:57856
    s_add_u32 m0, s27, 154624
    s_add_u32 s28, s52, 24576
    buffer_load_dwordx4 v4, s[12:15], s28 offen offset:2048 lds
    s_waitcnt lgkmcnt(0)
    v_mfma_f32_32x32x16_bf16 v[80:95], v[56:59], v[48:51], v[80:95]
    ds_read_b64_tr_b16 v[68:69], v25 offset:40960
    ds_read_b64_tr_b16 v[70:71], v25 offset:41472
    ds_read_b128 v[52:55], v13 offset:32768
    s_add_u32 m0, s27, 0
    s_nop 0
    buffer_load_dwordx4 v2, s[8:11], s45 offen lds
    v_mfma_f32_32x32x16_bf16 v[96:111], v[60:63], v[48:51], v[96:111]
    ds_read_b64_tr_b16 v[72:73], v25 offset:49152
    ds_read_b64_tr_b16 v[74:75], v25 offset:49664
    v_and_b32 v144, 0xffff0000, v48
    v_lshlrev_b32 v145, 16, v48
    v_and_b32 v146, 0xffff0000, v49
    v_lshlrev_b32 v147, 16, v49
    v_mfma_f32_32x32x16_bf16 v[112:127], v[48:51], v[64:67], v[112:127]
    ds_read_b64_tr_b16 v[76:77], v25 offset:57344
    ds_read_b64_tr_b16 v[78:79], v25 offset:57856
    v_and_b32 v148, 0xffff0000, v50
    v_lshlrev_b32 v149, 16, v50
    v_and_b32 v150, 0xffff0000, v51
    v_lshlrev_b32 v151, 16, v51
    v_mfma_f32_16x16x32_bf16 v[128:131], v[32:35], v[48:51], v[128:131]
    v_fmac_f32 v36, v144, v144
    v_fmac_f32 v37, v145, v145
    v_mfma_f32_16x16x32_bf16 v[132:135], v[32:35], v[56:59], v[132:135]
    v_fmac_f32 v36, v146, v146
    v_fmac_f32 v37, v147, v147
    v_mfma_f32_16x16x32_bf16 v[136:139], v[32:35], v[60:63], v[136:139]
    v_fmac_f32 v36, v148, v148
    v_fmac_f32 v37, v149, v149
    v_mfma_f32_16x16x32_bf16 v[140:143], v[32:35], v[64:67], v[140:143]
    v_fmac_f32 v36, v150, v150
    v_fmac_f32 v37, v151, v151
    s_waitcnt lgkmcnt(0)
    v_mfma_f32_32x32x16_bf16 v[80:95], v[68:71], v[52:55], v[80:95]
    ds_read_b64_tr_b16 v[56:57], v26 offset:40960
    ds_read_b64_tr_b16 v[58:59], v26 offset:41472
    ds_read_b128 v[48:51], v14 offset:32768
    s_add_u32 m0, s27, 8192
    s_add_u32 s28, s53, 0
    buffer_load_dwordx4 v4, s[12:15], s28 offen offset:0 lds
    v_mfma_f32_32x32x16_bf16 v[96:111], v[72:75], v[52:55], v[96:111]
    ds_read_b64_tr_b16 v[60:61], v26 offset:49152
    ds_read_b64_tr_b16 v[62:63], v26 offset:49664
    v_and_b32 v144, 0xffff0000, v52
    v_lshlrev_b32 v145, 16, v52
    v_and_b32 v146, 0xffff0000, v53
    v_lshlrev_b32 v147, 16, v53
    v_mfma_f32_32x32x16_bf16 v[112:127], v[52:55], v[76:79], v[112:127]
    ds_read_b64_tr_b16 v[64:65], v26 offset:57344
    ds_read_b64_tr_b16 v[66:67], v26 offset:57856
    v_and_b32 v148, 0xffff0000, v54
    v_lshlrev_b32 v149, 16, v54
    v_and_b32 v150, 0xffff0000, v55
    v_lshlrev_b32 v151, 16, v55
    v_mfma_f32_16x16x32_bf16 v[128:131], v[32:35], v[52:55], v[128:131]
    v_fmac_f32 v36, v144, v144
    v_fmac_f32 v37, v145, v145
    v_fmac_f32 v36, v146, v146
    v_fmac_f32 v37, v147, v147
    v_fmac_f32 v36, v148, v148
    v_fmac_f32 v37, v149, v149
    v_fmac_f32 v36, v150, v150
    v_fmac_f32 v37, v151, v151
    s_waitcnt lgkmcnt(0)
    v_mfma_f32_32x32x16_bf16 v[80:95], v[56:59], v[48:51], v[80:95]
    ds_read_b64_tr_b16 v[68:69], v27 offset:40960
    ds_read_b64_tr_b16 v[70:71], v27 offset:41472
    ds_read_b128 v[52:55], v15 offset:32768
    s_add_u32 m0, s27, 15360
    s_add_u32 s28, s53, 0
    buffer_load_dwordx4 v4, s[12:15], s28 offen offset:1024 lds
    v_mfma_f32_32x32x16_bf16 v[96:111], v[60:63], v[48:51], v[96:111]
    ds_read_b64_tr_b16 v[72:73], v27 offset:49152
    ds_read_b64_tr_b16 v[74:75], v27 offset:49664
    s_add_u32 m0, s27, 22528
    s_add_u32 s28, s53, 0
    buffer_load_dwordx4 v4, s[12:15], s28 offen offset:2048 lds
    v_mfma_f32_32x32x16_bf16 v[112:127], v[48:51], v[64:67], v[112:127]
    ds_read_b64_tr_b16 v[76:77], v27 offset:57344
    ds_read_b64_tr_b16 v[78:79], v27 offset:57856
    s_add_u32 m0, s27, 1024
    s_nop 0
    buffer_load_dwordx4 v3, s[8:11], s45 offen lds
    v_mfma_f32_16x16x32_bf16 v[132:135], v[32:35], v[56:59], v[132:135]
    v_mfma_f32_16x16x32_bf16 v[136:139], v[32:35], v[60:63], v[136:139]
    v_mfma_f32_16x16x32_bf16 v[140:143], v[32:35], v[64:67], v[140:143]
    s_waitcnt vmcnt(5)
    s_barrier
    s_waitcnt lgkmcnt(0)
    v_mfma_f32_32x32x16_bf16 v[80:95], v[68:71], v[52:55], v[80:95]
    ds_read_b64_tr_b16 v[56:57], v28 offset:8192
    ds_read_b64_tr_b16 v[58:59], v28 offset:8704
    ds_read_b128 v[48:51], v16 offset:0
    s_add_u32 m0, s27, 9216
    s_add_u32 s28, s53, 24576
    buffer_load_dwordx4 v4, s[12:15], s28 offen offset:0 lds
    v_mfma_f32_32x32x16_bf16 v[96:111], v[72:75], v[52:55], v[96:111]
    ds_read_b64_tr_b16 v[60:61], v28 offset:16384
    ds_read_b64_tr_b16 v[62:63], v28 offset:16896
    s_add_u32 m0, s27, 16384
    s_add_u32 s28, s53, 24576
    buffer_load_dwordx4 v4, s[12:15], s28 offen offset:1024 lds
    v_mfma_f32_32x32x16_bf16 v[112:127], v[52:55], v[76:79], v[112:127]
    ds_read_b64_tr_b16 v[64:65], v28 offset:24576
    ds_read_b64_tr_b16 v[66:67], v28 offset:25088
    s_add_u32 m0, s27, 23552
    s_add_u32 s28, s53, 24576
    buffer_load_dwordx4 v4, s[12:15], s28 offen offset:2048 lds
    s_waitcnt lgkmcnt(0)
    v_mfma_f32_32x32x16_bf16 v[80:95], v[56:59], v[48:51], v[80:95]
    ds_read_b64_tr_b16 v[68:69], v29 offset:8192
    ds_read_b64_tr_b16 v[70:71], v29 offset:8704
    ds_read_b128 v[52:55], v17 offset:0
    s_add_u32 m0, s27, 32768
    s_nop 0
    buffer_load_dwordx4 v2, s[8:11], s46 offen lds
    v_mfma_f32_32x32x16_bf16 v[96:111], v[60:63], v[48:51], v[96:111]
    ds_read_b64_tr_b16 v[72:73], v29 offset:16384
    ds_read_b64_tr_b16 v[74:75], v29 offset:16896
    v_and_b32 v144, 0xffff0000, v48
    v_lshlrev_b32 v145, 16, v48
    v_and_b32 v146, 0xffff0000, v49
    v_lshlrev_b32 v147, 16, v49
    v_mfma_f32_32x32x16_bf16 v[112:127], v[48:51], v[64:67], v[112:127]
    ds_read_b64_tr_b16 v[76:77], v29 offset:24576
    ds_read_b64_tr_b16 v[78:79], v29 offset:25088
    v_and_b32 v148, 0xffff0000, v50
    v_lshlrev_b32 v149, 16, v50
    v_and_b32 v150, 0xffff0000, v51
    v_lshlrev_b32 v151, 16, v51
    v_mfma_f32_16x16x32_bf16 v[128:131], v[32:35], v[48:51], v[128:131]
    v_fmac_f32 v36, v144, v144
    v_fmac_f32 v37, v145, v145
    v_mfma_f32_16x16x32_bf16 v[132:135], v[32:35], v[56:59], v[132:135]
    v_fmac_f32 v36, v146, v146
    v_fmac_f32 v37, v147, v147
    v_mfma_f32_16x16x32_bf16 v[136:139], v[32:35], v[60:63], v[136:139]
    v_fmac_f32 v36, v148, v148
    v_fmac_f32 v37, v149, v149
    v_mfma_f32_16x16x32_bf16 v[140:143], v[32:35], v[64:67], v[140:143]
    v_fmac_f32 v36, v150, v150
    v_fmac_f32 v37, v151, v151
    s_waitcnt lgkmcnt(0)
    v_mfma_f32_32x32x16_bf16 v[80:95], v[68:71], v[52:55], v[80:95]
    ds_read_b64_tr_b16 v[56:57], v30 offset:8192
    ds_read_b64_tr_b16 v[58:59], v30 offset:8704
    ds_read_b128 v[48:51], v18 offset:0
    s_add_u32 m0, s27, 40960
    s_add_u32 s28, s54, 0
    buffer_load_dwordx4 v4, s[12:15], s28 offen offset:0 lds
    v_mfma_f32_32x32x16_bf16 v[96:111], v[72:75], v[52:55], v[96:111]
    ds_read_b64_tr_b16 v[60:61], v30 offset:16384
    ds_read_b64_tr_b16 v[62:63], v30 offset:16896
    v_and_b32 v144, 0xffff0000, v52
    v_lshlrev_b32 v145, 16, v52
    v_and_b32 v146, 0xffff0000, v53
    v_lshlrev_b32 v147, 16, v53
    v_mfma_f32_32x32x16_bf16 v[112:127], v[52:55], v[76:79], v[112:127]
    ds_read_b64_tr_b16 v[64:65], v30 offset:24576
    ds_read_b64_tr_b16 v[66:67], v30 offset:25088
    v_and_b32 v148, 0xffff0000, v54
    v_lshlrev_b32 v149, 16, v54
    v_and_b32 v150, 0xffff0000, v55
    v_lshlrev_b32 v151, 16, v55
    v_mfma_f32_16x16x32_bf16 v[128:131], v[32:35], v[52:55], v[128:131]
    v_fmac_f32 v36, v144, v144
    v_fmac_f32 v37, v145, v145
    v_fmac_f32 v36, v146, v146
    v_fmac_f32 v37, v147, v147
    v_fmac_f32 v36, v148, v148
    v_fmac_f32 v37, v149, v149
    v_fmac_f32 v36, v150, v150
    v_fmac_f32 v37, v151, v151
    s_waitcnt lgkmcnt(0)
    v_mfma_f32_32x32x16_bf16 v[80:95], v[56:59], v[48:51], v[80:95]
    ds_read_b64_tr_b16 v[68:69], v31 offset:8192
    ds_read_b64_tr_b16 v[70:71], v31 offset:8704
    ds_read_b128 v[52:55], v19 offset:0
    s_add_u32 m0, s27, 48128
    s_add_u32 s28, s54, 0
    buffer_load_dwordx4 v4, s[12:15], s28 offen offset:1024 lds
    v_mfma_f32_32x32x16_bf16 v[96:111], v[60:63], v[48:51], v[96:111]
    ds_read_b64_tr_b16 v[72:73], v31 offset:16384
    ds_read_b64_tr_b16 v[74:75], v31 offset:16896
    s_add_u32 m0, s27, 55296
    s_add_u32 s28, s54, 0
    buffer_load_dwordx4 v4, s[12:15], s28 offen offset:2048 lds
    v_mfma_f32_32x32x16_bf16 v[112:127], v[48:51], v[64:67], v[112:127]
    ds_read_b64_tr_b16 v[76:77], v31 offset:24576
    ds_read_b64_tr_b16 v[78:79], v31 offset:25088
    s_add_u32 m0, s27, 33792
    s_nop 0
    buffer_load_dwordx4 v3, s[8:11], s46 offen lds
    v_mfma_f32_16x16x32_bf16 v[132:135], v[32:35], v[56:59], v[132:135]
    v_mfma_f32_16x16x32_bf16 v[136:139], v[32:35], v[60:63], v[136:139]
    v_mfma_f32_16x16x32_bf16 v[140:143], v[32:35], v[64:67], v[140:143]
    s_waitcnt vmcnt(5)
    s_barrier
    s_waitcnt lgkmcnt(0)
    v_mfma_f32_32x32x16_bf16 v[80:95], v[68:71], v[52:55], v[80:95]
    ds_read_b64_tr_b16 v[56:57], v20 offset:8192
    ds_read_b64_tr_b16 v[58:59], v20 offset:8704
    ds_read_b128 v[48:51], v8 offset:0
    s_add_u32 m0, s27, 41984
    s_add_u32 s28, s54, 24576
    buffer_load_dwordx4 v4, s[12:15], s28 offen offset:0 lds
    v_mfma_f32_32x32x16_bf16 v[96:111], v[72:75], v[52:55], v[96:111]
    ds_read_b64_tr_b16 v[60:61], v20 offset:16384
    ds_read_b64_tr_b16 v[62:63], v20 offset:16896
    s_add_u32 m0, s27, 49152
    s_add_u32 s28, s54, 24576
    buffer_load_dwordx4 v4, s[12:15], s28 offen offset:1024 lds
    v_mfma_f32_32x32x16_bf16 v[112:127], v[52:55], v[76:79], v[112:127]
    ds_read_b64_tr_b16 v[64:65], v20 offset:24576
    ds_read_b64_tr_b16 v[66:67], v20 offset:25088
    s_add_u32 m0, s27, 56320
    s_add_u32 s28, s54, 24576
    buffer_load_dwordx4 v4, s[12:15], s28 offen offset:2048 lds
    s_waitcnt lgkmcnt(0)
    v_mfma_f32_32x32x16_bf16 v[80:95], v[56:59], v[48:51], v[80:95]
    ds_read_b64_tr_b16 v[68:69], v21 offset:8192
    ds_read_b64_tr_b16 v[70:71], v21 offset:8704
    ds_read_b128 v[52:55], v9 offset:0
    s_add_u32 m0, s27, 65536
    s_nop 0
    buffer_load_dwordx4 v2, s[8:11], s47 offen lds
    v_mfma_f32_32x32x16_bf16 v[96:111], v[60:63], v[48:51], v[96:111]
    ds_read_b64_tr_b16 v[72:73], v21 offset:16384
    ds_read_b64_tr_b16 v[74:75], v21 offset:16896
    v_and_b32 v144, 0xffff0000, v48
    v_lshlrev_b32 v145, 16, v48
    v_and_b32 v146, 0xffff0000, v49
    v_lshlrev_b32 v147, 16, v49
    v_mfma_f32_32x32x16_bf16 v[112:127], v[48:51], v[64:67], v[112:127]
    ds_read_b64_tr_b16 v[76:77], v21 offset:24576
    ds_read_b64_tr_b16 v[78:79], v21 offset:25088
    v_and_b32 v148, 0xffff0000, v50
    v_lshlrev_b32 v149, 16, v50
    v_and_b32 v150, 0xffff0000, v51
    v_lshlrev_b32 v151, 16, v51
    v_mfma_f32_16x16x32_bf16 v[128:131], v[32:35], v[48:51], v[128:131]
    v_fmac_f32 v36, v144, v144
    v_fmac_f32 v37, v145, v145
    v_mfma_f32_16x16x32_bf16 v[132:135], v[32:35], v[56:59], v[132:135]
    v_fmac_f32 v36, v146, v146
    v_fmac_f32 v37, v147, v147
    v_mfma_f32_16x16x32_bf16 v[136:139], v[32:35], v[60:63], v[136:139]
    v_fmac_f32 v36, v148, v148
    v_fmac_f32 v37, v149, v149
    v_mfma_f32_16x16x32_bf16 v[140:143], v[32:35], v[64:67], v[140:143]
    v_fmac_f32 v36, v150, v150
    v_fmac_f32 v37, v151, v151
    s_waitcnt lgkmcnt(0)
    v_mfma_f32_32x32x16_bf16 v[80:95], v[68:71], v[52:55], v[80:95]
    ds_read_b64_tr_b16 v[56:57], v22 offset:8192
    ds_read_b64_tr_b16 v[58:59], v22 offset:8704
    ds_read_b128 v[48:51], v10 offset:0
    s_add_u32 m0, s27, 73728
    s_add_u32 s28, s55, 0
    buffer_load_dwordx4 v4, s[12:15], s28 offen offset:0 lds
    v_mfma_f32_32x32x16_bf16 v[96:111], v[72:75], v[52:55], v[96:111]
    ds_read_b64_tr_b16 v[60:61], v22 offset:16384
    ds_read_b64_tr_b16 v[62:63], v22 offset:16896
    v_and_b32 v144, 0xffff0000, v52
    v_lshlrev_b32 v145, 16, v52
    v_and_b32 v146, 0xffff0000, v53
    v_lshlrev_b32 v147, 16, v53
    v_mfma_f32_32x32x16_bf16 v[112:127], v[52:55], v[76:79], v[112:127]
    ds_read_b64_tr_b16 v[64:65], v22 offset:24576
    ds_read_b64_tr_b16 v[66:67], v22 offset:25088
    v_and_b32 v148, 0xffff0000, v54
    v_lshlrev_b32 v149, 16, v54
    v_and_b32 v150, 0xffff0000, v55
    v_lshlrev_b32 v151, 16, v55
    v_mfma_f32_16x16x32_bf16 v[128:131], v[32:35], v[52:55], v[128:131]
    v_fmac_f32 v36, v144, v144
    v_fmac_f32 v37, v145, v145
    v_fmac_f32 v36, v146, v146
    v_fmac_f32 v37, v147, v147
    v_fmac_f32 v36, v148, v148
    v_fmac_f32 v37, v149, v149
    v_fmac_f32 v36, v150, v150
    v_fmac_f32 v37, v151, v151
    s_waitcnt lgkmcnt(0)
    v_mfma_f32_32x32x16_bf16 v[80:95], v[56:59], v[48:51], v[80:95]
    ds_read_b64_tr_b16 v[68:69], v23 offset:8192
    ds_read_b64_tr_b16 v[70:71], v23 offset:8704
    ds_read_b128 v[52:55], v11 offset:0
    s_add_u32 m0, s27, 80896
    s_add_u32 s28, s55, 0
    buffer_load_dwordx4 v4, s[12:15], s28 offen offset:1024 lds
    v_mfma_f32_32x32x16_bf16 v[96:111], v[60:63], v[48:51], v[96:111]
    ds_read_b64_tr_b16 v[72:73], v23 offset:16384
    ds_read_b64_tr_b16 v[74:75], v23 offset:16896
    s_add_u32 m0, s27, 88064
    s_add_u32 s28, s55, 0
    buffer_load_dwordx4 v4, s[12:15], s28 offen offset:2048 lds
    v_mfma_f32_32x32x16_bf16 v[112:127], v[48:51], v[64:67], v[112:127]
    ds_read_b64_tr_b16 v[76:77], v23 offset:24576
    ds_read_b64_tr_b16 v[78:79], v23 offset:25088
    s_add_u32 m0, s27, 66560
    s_nop 0
    buffer_load_dwordx4 v3, s[8:11], s47 offen lds
    v_mfma_f32_16x16x32_bf16 v[132:135], v[32:35], v[56:59], v[132:135]
    v_mfma_f32_16x16x32_bf16 v[136:139], v[32:35], v[60:63], v[136:139]
    v_mfma_f32_16x16x32_bf16 v[140:143], v[32:35], v[64:67], v[140:143]
    s_waitcnt vmcnt(5)
    s_barrier
    s_waitcnt lgkmcnt(0)
    v_mfma_f32_32x32x16_bf16 v[80:95], v[68:71], v[52:55], v[80:95]
    ds_read_b64_tr_b16 v[56:57], v20 offset:40960
    ds_read_b64_tr_b16 v[58:59], v20 offset:41472
    ds_read_b128 v[48:51], v8 offset:32768
    s_add_u32 m0, s27, 74752
    s_add_u32 s28, s55, 24576
    buffer_load_dwordx4 v4, s[12:15], s28 offen offset:0 lds
    v_mfma_f32_32x32x16_bf16 v[96:111], v[72:75], v[52:55], v[96:111]
    ds_read_b64_tr_b16 v[60:61], v20 offset:49152
    ds_read_b64_tr_b16 v[62:63], v20 offset:49664
    s_add_u32 m0, s27, 81920
    s_add_u32 s28, s55, 24576
    buffer_load_dwordx4 v4, s[12:15], s28 offen offset:1024 lds
    v_mfma_f32_32x32x16_bf16 v[112:127], v[52:55], v[76:79], v[112:127]
    ds_read_b64_tr_b16 v[64:65], v20 offset:57344
    ds_read_b64_tr_b16 v[66:67], v20 offset:57856
    s_add_u32 m0, s27, 89088
    s_add_u32 s28, s55, 24576
    buffer_load_dwordx4 v4, s[12:15], s28 offen offset:2048 lds
    s_waitcnt lgkmcnt(0)
    v_mfma_f32_32x32x16_bf16 v[80:95], v[56:59], v[48:51], v[80:95]
    ds_read_b64_tr_b16 v[68:69], v21 offset:40960
    ds_read_b64_tr_b16 v[70:71], v21 offset:41472
    ds_read_b128 v[52:55], v9 offset:32768
    v_and_b32 v144, 0xffff0000, v48
    v_lshlrev_b32 v145, 16, v48
    v_and_b32 v146, 0xffff0000, v49
    v_mfma_f32_32x32x16_bf16 v[96:111], v[60:63], v[48:51], v[96:111]
    ds_read_b64_tr_b16 v[72:73], v21 offset:49152
    ds_read_b64_tr_b16 v[74:75], v21 offset:49664
    v_lshlrev_b32 v147, 16, v49
    v_and_b32 v148, 0xffff0000, v50
    v_lshlrev_b32 v149, 16, v50
    v_and_b32 v150, 0xffff0000, v51
    v_mfma_f32_32x32x16_bf16 v[112:127], v[48:51], v[64:67], v[112:127]
    ds_read_b64_tr_b16 v[76:77], v21 offset:57344
    ds_read_b64_tr_b16 v[78:79], v21 offset:57856
    v_lshlrev_b32 v151, 16, v51
    v_fmac_f32 v36, v144, v144
    v_fmac_f32 v37, v145, v145
    v_fmac_f32 v36, v146, v146
    v_mfma_f32_16x16x32_bf16 v[128:131], v[32:35], v[48:51], v[128:131]
    v_fmac_f32 v37, v147, v147
    v_fmac_f32 v36, v148, v148
    v_mfma_f32_16x16x32_bf16 v[132:135], v[32:35], v[56:59], v[132:135]
    v_fmac_f32 v37, v149, v149
    v_fmac_f32 v36, v150, v150
    v_mfma_f32_16x16x32_bf16 v[136:139], v[32:35], v[60:63], v[136:139]
    v_fmac_f32 v37, v151, v151
    v_mfma_f32_16x16x32_bf16 v[140:143], v[32:35], v[64:67], v[140:143]
    s_waitcnt lgkmcnt(0)
    v_mfma_f32_32x32x16_bf16 v[80:95], v[68:71], v[52:55], v[80:95]
    ds_read_b64_tr_b16 v[56:57], v22 offset:40960
    ds_read_b64_tr_b16 v[58:59], v22 offset:41472
    ds_read_b128 v[48:51], v10 offset:32768
    v_and_b32 v144, 0xffff0000, v52
    v_lshlrev_b32 v145, 16, v52
    v_and_b32 v146, 0xffff0000, v53
    v_mfma_f32_32x32x16_bf16 v[96:111], v[72:75], v[52:55], v[96:111]
    ds_read_b64_tr_b16 v[60:61], v22 offset:49152
    ds_read_b64_tr_b16 v[62:63], v22 offset:49664
    v_lshlrev_b32 v147, 16, v53
    v_and_b32 v148, 0xffff0000, v54
    v_lshlrev_b32 v149, 16, v54
    v_and_b32 v150, 0xffff0000, v55
    v_mfma_f32_32x32x16_bf16 v[112:127], v[52:55], v[76:79], v[112:127]
    ds_read_b64_tr_b16 v[64:65], v22 offset:57344
    ds_read_b64_tr_b16 v[66:67], v22 offset:57856
    v_lshlrev_b32 v151, 16, v55
    v_fmac_f32 v36, v144, v144
    v_fmac_f32 v37, v145, v145
    v_fmac_f32 v36, v146, v146
    v_mfma_f32_16x16x32_bf16 v[128:131], v[32:35], v[52:55], v[128:131]
    v_fmac_f32 v37, v147, v147
    v_fmac_f32 v36, v148, v148
    v_fmac_f32 v37, v149, v149
    v_fmac_f32 v36, v150, v150
    v_fmac_f32 v37, v151, v151
    s_waitcnt lgkmcnt(0)
    v_mfma_f32_32x32x16_bf16 v[80:95], v[56:59], v[48:51], v[80:95]
    ds_read_b64_tr_b16 v[68:69], v23 offset:40960
    ds_read_b64_tr_b16 v[70:71], v23 offset:41472
    ds_read_b128 v[52:55], v11 offset:32768
    v_mfma_f32_32x32x16_bf16 v[96:111], v[60:63], v[48:51], v[96:111]
    ds_read_b64_tr_b16 v[72:73], v23 offset:49152
    ds_read_b64_tr_b16 v[74:75], v23 offset:49664
    v_mfma_f32_32x32x16_bf16 v[112:127], v[48:51], v[64:67], v[112:127]
    ds_read_b64_tr_b16 v[76:77], v23 offset:57344
    ds_read_b64_tr_b16 v[78:79], v23 offset:57856
    v_mfma_f32_16x16x32_bf16 v[132:135], v[32:35], v[56:59], v[132:135]
    v_mfma_f32_16x16x32_bf16 v[136:139], v[32:35], v[60:63], v[136:139]
    v_mfma_f32_16x16x32_bf16 v[140:143], v[32:35], v[64:67], v[140:143]
    s_waitcnt vmcnt(0)
    s_barrier
    s_waitcnt lgkmcnt(0)
    v_mfma_f32_32x32x16_bf16 v[80:95], v[68:71], v[52:55], v[80:95]
    ds_read_b64_tr_b16 v[56:57], v24 offset:8192
    ds_read_b64_tr_b16 v[58:59], v24 offset:8704
    ds_read_b128 v[48:51], v12 offset:0
    v_mfma_f32_32x32x16_bf16 v[96:111], v[72:75], v[52:55], v[96:111]
    ds_read_b64_tr_b16 v[60:61], v24 offset:16384
    ds_read_b64_tr_b16 v[62:63], v24 offset:16896
    v_mfma_f32_32x32x16_bf16 v[112:127], v[52:55], v[76:79], v[112:127]
    ds_read_b64_tr_b16 v[64:65], v24 offset:24576
    ds_read_b64_tr_b16 v[66:67], v24 offset:25088
    s_waitcnt lgkmcnt(0)
    v_mfma_f32_32x32x16_bf16 v[80:95], v[56:59], v[48:51], v[80:95]
    ds_read_b64_tr_b16 v[68:69], v25 offset:8192
    ds_read_b64_tr_b16 v[70:71], v25 offset:8704
    ds_read_b128 v[52:55], v13 offset:0
    v_and_b32 v144, 0xffff0000, v48
    v_lshlrev_b32 v145, 16, v48
    v_and_b32 v146, 0xffff0000, v49
    v_mfma_f32_32x32x16_bf16 v[96:111], v[60:63], v[48:51], v[96:111]
    ds_read_b64_tr_b16 v[72:73], v25 offset:16384
    ds_read_b64_tr_b16 v[74:75], v25 offset:16896
    v_lshlrev_b32 v147, 16, v49
    v_and_b32 v148, 0xffff0000, v50
    v_lshlrev_b32 v149, 16, v50
    v_and_b32 v150, 0xffff0000, v51
    v_mfma_f32_32x32x16_bf16 v[112:127], v[48:51], v[64:67], v[112:127]
    ds_read_b64_tr_b16 v[76:77], v25 offset:24576
    ds_read_b64_tr_b16 v[78:79], v25 offset:25088
    v_lshlrev_b32 v151, 16, v51
    v_fmac_f32 v36, v144, v144
    v_fmac_f32 v37, v145, v145
    v_fmac_f32 v36, v146, v146
    v_mfma_f32_16x16x32_bf16 v[128:131], v[32:35], v[48:51], v[128:131]
    v_fmac_f32 v37, v147, v147
    v_fmac_f32 v36, v148, v148
    v_mfma_f32_16x16x32_bf16 v[132:135], v[32:35], v[56:59], v[132:135]
    v_fmac_f32 v37, v149, v149
    v_fmac_f32 v36, v150, v150
    v_mfma_f32_16x16x32_bf16 v[136:139], v[32:35], v[60:63], v[136:139]
    v_fmac_f32 v37, v151, v151
    v_mfma_f32_16x16x32_bf16 v[140:143], v[32:35], v[64:67], v[140:143]
    s_waitcnt lgkmcnt(0)
    v_mfma_f32_32x32x16_bf16 v[80:95], v[68:71], v[52:55], v[80:95]
    ds_read_b64_tr_b16 v[56:57], v26 offset:8192
    ds_read_b64_tr_b16 v[58:59], v26 offset:8704
    ds_read_b128 v[48:51], v14 offset:0
    v_and_b32 v144, 0xffff0000, v52
    v_lshlrev_b32 v145, 16, v52
    v_and_b32 v146, 0xffff0000, v53
    v_mfma_f32_32x32x16_bf16 v[96:111], v[72:75], v[52:55], v[96:111]
    ds_read_b64_tr_b16 v[60:61], v26 offset:16384
    ds_read_b64_tr_b16 v[62:63], v26 offset:16896
    v_lshlrev_b32 v147, 16, v53
    v_and_b32 v148, 0xffff0000, v54
    v_lshlrev_b32 v149, 16, v54
    v_and_b32 v150, 0xffff0000, v55
    v_mfma_f32_32x32x16_bf16 v[112:127], v[52:55], v[76:79], v[112:127]
    ds_read_b64_tr_b16 v[64:65], v26 offset:24576
    ds_read_b64_tr_b16 v[66:67], v26 offset:25088
    v_lshlrev_b32 v151, 16, v55
    v_fmac_f32 v36, v144, v144
    v_fmac_f32 v37, v145, v145
    v_fmac_f32 v36, v146, v146
    v_mfma_f32_16x16x32_bf16 v[128:131], v[32:35], v[52:55], v[128:131]
    v_fmac_f32 v37, v147, v147
    v_fmac_f32 v36, v148, v148
    v_fmac_f32 v37, v149, v149
    v_fmac_f32 v36, v150, v150
    v_fmac_f32 v37, v151, v151
    v_add_f32 v36, v36, v37
    v_mov_b32 v37, v36
    s_nop 1
    v_permlane32_swap_b32 v36, v37
    v_add_f32 v36, v36, v37
    s_waitcnt lgkmcnt(0)
    v_mfma_f32_32x32x16_bf16 v[80:95], v[56:59], v[48:51], v[80:95]
    ds_read_b64_tr_b16 v[68:69], v27 offset:8192
    ds_read_b64_tr_b16 v[70:71], v27 offset:8704
    ds_read_b128 v[52:55], v15 offset:0
    v_mfma_f32_32x32x16_bf16 v[96:111], v[60:63], v[48:51], v[96:111]
    ds_read_b64_tr_b16 v[72:73], v27 offset:16384
    ds_read_b64_tr_b16 v[74:75], v27 offset:16896
    v_mfma_f32_32x32x16_bf16 v[112:127], v[48:51], v[64:67], v[112:127]
    ds_read_b64_tr_b16 v[76:77], v27 offset:24576
    ds_read_b64_tr_b16 v[78:79], v27 offset:25088
    v_mfma_f32_16x16x32_bf16 v[132:135], v[32:35], v[56:59], v[132:135]
    v_mfma_f32_16x16x32_bf16 v[136:139], v[32:35], v[60:63], v[136:139]
    v_mfma_f32_16x16x32_bf16 v[140:143], v[32:35], v[64:67], v[140:143]
    s_waitcnt lgkmcnt(0)
    v_mfma_f32_32x32x16_bf16 v[80:95], v[68:71], v[52:55], v[80:95]
    v_cndmask_b32 v42, v36, v128, vcc
    ds_write_b32 v212, v42
    s_nop 2
    v_cndmask_b32 v43, v136, v132, vcc
    ds_write_b32 v212, v43 offset:256
    ds_write_b32 v212, v140 offset:512
    v_mfma_f32_32x32x16_bf16 v[96:111], v[72:75], v[52:55], v[96:111]
    s_waitcnt lgkmcnt(0)
    s_barrier
    ds_read_b32 v144, v213
    ds_read_b32 v145, v213 offset:128
    ds_read_b32 v146, v214 offset:256
    ds_read_b32 v147, v214 offset:384
    ds_read_b32 v148, v214 offset:512
    v_mfma_f32_32x32x16_bf16 v[112:127], v[52:55], v[76:79], v[112:127]
    s_waitcnt lgkmcnt(3)
    v_add_f32 v144, v144, v128
    v_add_f32 v36, v36, v145
    v_mul_f32 v38, 0xbb000000, v144
    v_mul_f32 v36, 0x3b000000, v36
    v_fma_f32 v36, -v38, v38, v36
    v_max_f32 v36, 0, v36
    v_add_f32 v36, 0x3727c5ac, v36
    v_rsq_f32 v39, v36
    v_mul_f32 v38, v38, v219
    v_and_b32 v208, 0xffff0000, v38
    v_sub_f32 v210, v38, v208
    v_and_b32 v209, 0xffff0000, v210
    v_sub_f32 v210, v210, v209
    v_and_b32 v210, 0xffff0000, v210
    ds_write_b32 v212, v39 offset:1024
    v_lshrrev_b32 v192, 16, v208
    v_or_b32 v192, v192, v209
    v_lshrrev_b32 v193, 16, v208
    v_or_b32 v193, v193, v210
    v_mov_b32 v194, v192
    ds_read_b128 v[152:155], v217 offset:1024
    ds_read_b128 v[156:159], v217 offset:1056
    ds_read_b128 v[160:163], v217 offset:1088
    ds_read_b128 v[164:167], v217 offset:1120
    s_waitcnt lgkmcnt(5)
    v_add_f32 v148, v148, v140
    v_and_b32 v208, 0xffff0000, v148
    v_sub_f32 v210, v148, v208
    v_and_b32 v209, 0xffff0000, v210
    v_sub_f32 v210, v210, v209
    v_and_b32 v210, 0xffff0000, v210
    v_lshrrev_b32 v204, 16, v208
    v_or_b32 v204, v204, v208
    v_lshrrev_b32 v205, 16, v209
    v_or_b32 v205, v205, v208
    v_lshrrev_b32 v206, 16, v210
    v_or_b32 v206, v206, v209
    s_nop 1
    v_mfma_f32_32x32x16_bf16 v[112:127], v[192:195], v[204:207], v[112:127]
    v_add_f32 v147, v147, v136
    v_and_b32 v208, 0xffff0000, v147
    v_sub_f32 v210, v147, v208
    v_and_b32 v209, 0xffff0000, v210
    v_sub_f32 v210, v210, v209
    v_and_b32 v210, 0xffff0000, v210
    v_lshrrev_b32 v200, 16, v208
    v_or_b32 v200, v200, v208
    v_lshrrev_b32 v201, 16, v209
    v_or_b32 v201, v201, v208
    v_lshrrev_b32 v202, 16, v210
    v_or_b32 v202, v202, v209
    s_nop 1
    v_mfma_f32_32x32x16_bf16 v[96:111], v[200:203], v[192:195], v[96:111]
    v_add_f32 v146, v146, v132
    v_and_b32 v208, 0xffff0000, v146
    v_sub_f32 v210, v146, v208
    v_and_b32 v209, 0xffff0000, v210
    v_sub_f32 v210, v210, v209
    v_and_b32 v210, 0xffff0000, v210
    v_lshrrev_b32 v196, 16, v208
    v_or_b32 v196, v196, v208
    v_lshrrev_b32 v197, 16, v209
    v_or_b32 v197, v197, v208
    v_lshrrev_b32 v198, 16, v210
    v_or_b32 v198, v198, v209
    s_nop 1
    v_mfma_f32_32x32x16_bf16 v[80:95], v[196:199], v[192:195], v[80:95]
    v_mov_b32 v40, v39
    v_mov_b32 v41, v39
    v_mul_f32 v42, 0x3eb8aa3b, v39
    v_mov_b32 v43, v42
    s_waitcnt lgkmcnt(0)
    v_mul_f32 v112, v112, v152
    v_mul_f32 v113, v113, v153
    v_mul_f32 v114, v114, v154
    v_mul_f32 v115, v115, v155
    v_mul_f32 v116, v116, v156
    v_mul_f32 v117, v117, v157
    v_mul_f32 v118, v118, v158
    v_mul_f32 v119, v119, v159
    v_mul_f32 v120, v120, v160
    v_mul_f32 v121, v121, v161
    v_mul_f32 v122, v122, v162
    v_mul_f32 v123, v123, v163
    v_mul_f32 v124, v124, v164
    v_mul_f32 v125, v125, v165
    v_mul_f32 v126, v126, v166
    v_mul_f32 v127, v127, v167
    v_cvt_pk_bf16_f32 v168, v112, v113
    v_cvt_pk_bf16_f32 v169, v114, v115
    v_cvt_pk_bf16_f32 v170, v116, v117
    v_cvt_pk_bf16_f32 v171, v118, v119
    v_cvt_pk_bf16_f32 v172, v120, v121
    v_cvt_pk_bf16_f32 v173, v122, v123
    v_cvt_pk_bf16_f32 v174, v124, v125
    v_cvt_pk_bf16_f32 v175, v126, v127
    buffer_store_dwordx4 v[168:171], v216, s[16:19], s34 offen sc1
    buffer_store_dwordx4 v[172:175], v216, s[16:19], s34 offen offset:512 sc1
    v_pk_mul_f32 v[96:97], v[96:97], v[40:41]
    v_pk_mul_f32 v[98:99], v[98:99], v[40:41]
    v_pk_mul_f32 v[100:101], v[100:101], v[40:41]
    v_pk_mul_f32 v[102:103], v[102:103], v[40:41]
    v_pk_mul_f32 v[104:105], v[104:105], v[40:41]
    v_pk_mul_f32 v[106:107], v[106:107], v[40:41]
    v_pk_mul_f32 v[108:109], v[108:109], v[40:41]
    v_pk_mul_f32 v[110:111], v[110:111], v[40:41]
    v_cvt_pk_bf16_f32 v176, v96, v97
    v_cvt_pk_bf16_f32 v177, v98, v99
    v_cvt_pk_bf16_f32 v178, v100, v101
    v_cvt_pk_bf16_f32 v179, v102, v103
    v_cvt_pk_bf16_f32 v180, v104, v105
    v_cvt_pk_bf16_f32 v181, v106, v107
    v_cvt_pk_bf16_f32 v182, v108, v109
    v_cvt_pk_bf16_f32 v183, v110, v111
    buffer_store_dwordx4 v[176:179], v215, s[16:19], s35 offen sc1
    buffer_store_dwordx4 v[180:183], v215, s[16:19], s36 offen sc1
    v_pk_mul_f32 v[80:81], v[80:81], v[42:43]
    v_pk_mul_f32 v[82:83], v[82:83], v[42:43]
    v_pk_mul_f32 v[84:85], v[84:85], v[42:43]
    v_pk_mul_f32 v[86:87], v[86:87], v[42:43]
    v_pk_mul_f32 v[88:89], v[88:89], v[42:43]
    v_pk_mul_f32 v[90:91], v[90:91], v[42:43]
    v_pk_mul_f32 v[92:93], v[92:93], v[42:43]
    v_pk_mul_f32 v[94:95], v[94:95], v[42:43]
    v_cvt_pk_bf16_f32 v184, v80, v81
    v_cvt_pk_bf16_f32 v185, v82, v83
    v_cvt_pk_bf16_f32 v186, v84, v85
    v_cvt_pk_bf16_f32 v187, v86, v87
    v_cvt_pk_bf16_f32 v188, v88, v89
    v_cvt_pk_bf16_f32 v189, v90, v91
    v_cvt_pk_bf16_f32 v190, v92, v93
    v_cvt_pk_bf16_f32 v191, v94, v95
    buffer_store_dwordx4 v[184:187], v215, s[16:19], 0 offen sc1
    buffer_store_dwordx4 v[188:191], v215, s[16:19], s37 offen sc1
    v_mov_b32 v40, 0
    v_mov_b32 v41, 0
    v_dot2c_f32_bf16 v40, v176, v176
    v_dot2c_f32_bf16 v41, v180, v180
    v_dot2c_f32_bf16 v40, v177, v177
    v_dot2c_f32_bf16 v41, v181, v181
    v_dot2c_f32_bf16 v40, v178, v178
    v_dot2c_f32_bf16 v41, v182, v182
    v_dot2c_f32_bf16 v40, v179, v179
    v_dot2c_f32_bf16 v41, v183, v183
    s_nop 2
    v_permlane32_swap_b32 v40, v41
    v_add_f32 v40, v40, v41
    s_nop 1
    v_max_f32_dpp v40, v40, v40 row_shr:1 row_mask:0xf bank_mask:0xf bound_ctrl:0
    s_nop 1
    v_max_f32_dpp v40, v40, v40 row_shr:2 row_mask:0xf bank_mask:0xf bound_ctrl:0
    s_nop 1
    v_max_f32_dpp v40, v40, v40 row_shr:4 row_mask:0xf bank_mask:0xf bound_ctrl:0
    s_nop 1
    v_max_f32_dpp v40, v40, v40 row_shr:8 row_mask:0xf bank_mask:0xf bound_ctrl:0
    s_nop 1
    v_max_f32_dpp v40, v40, v40 row_bcast:15 row_mask:0xa bank_mask:0xf
    s_mov_b64 exec, s[38:39]
    buffer_store_dword v40, v218, s[16:19], s33 offen
L_k1_end:
    s_endpgm
.globl k2_attn_kernel
.p2align 8
.type k2_attn_kernel,@function
k2_attn_kernel:
    s_cmp_ge_u32 s2, 256
    s_cbranch_scc1 L_k2_end
    s_load_dwordx2 s[16:17], s[0:1], 72
    s_load_dwordx2 s[40:41], s[0:1], 16
    s_load_dwordx4 s[44:47], s[0:1], 32
    s_load_dwordx2 s[42:43], s[0:1], 48
    s_load_dwordx2 s[4:5], s[0:1], 56
    s_setprio 3
    v_and_b32 v1, 63, v0
    v_lshrrev_b32 v2, 6, v0
    s_and_b32 s21, s2, 31
    s_lshr_b32 s22, s2, 5
    v_readfirstlane_b32 s20, v2
    v_lshlrev_b32 v2, 4, v1
    s_lshl_b32 s23, s21, 16
    s_and_b32 s64, s20, 7
    s_lshr_b32 s65, s20, 3
    s_lshl_b32 s66, s65, 15
    s_lshl_b32 s24, s64, 10
    s_add_u32 s24, s24, s66
    s_add_u32 s25, s23, s24
    s_lshl_b32 s26, s22, 3
    s_add_u32 s26, s26, s64
    s_lshl_b32 s27, s26, 10
    s_add_u32 s27, s27, s23
    s_mov_b32 s18, 0x10000000
    s_mov_b32 s19, 0x00020000
    v_add_u32 v3, s25, v2
    s_lshl_b32 s28, s21, 8
    s_add_u32 s28, s28, 16515072
    v_lshlrev_b32 v4, 2, v1
    s_waitcnt lgkmcnt(0)
    buffer_load_dwordx4 v[8:11], v2, s[16:19], s27 offen
    buffer_load_dword v5, v4, s[16:19], s28 offen
    s_add_u32 m0, s24, 0
    s_mov_b32 s29, 2097152
    buffer_load_dwordx4 v3, s[16:19], s29 offen lds
    s_add_u32 m0, s24, 65536
    s_mov_b32 s29, 4194304
    buffer_load_dwordx4 v3, s[16:19], s29 offen lds
    v_and_b32 v6, 27, v1
    v_cmp_eq_u32 vcc, 16, v6
    v_mov_b32 v7, 0x3f803f80
    s_nop 0
    v_cndmask_b32 v6, 0, v7, vcc
    v_mov_b32 v96, v6
    v_mov_b32 v97, v6
    v_mov_b32 v98, v6
    v_mov_b32 v99, v6
    v_mov_b32 v100, v6
    v_mov_b32 v101, v6
    v_mov_b32 v102, v6
    v_mov_b32 v103, v6
    v_mov_b32 v104, v6
    v_mov_b32 v105, v6
    v_mov_b32 v106, v6
    v_mov_b32 v107, v6
    v_mov_b32 v108, v6
    v_mov_b32 v109, v6
    v_mov_b32 v110, v6
    v_mov_b32 v111, v6
    s_mov_b32 s60, 0x0000ffff
    s_mov_b32 s61, 0x0000ffff
    v_lshrrev_b32 v6, 5, v1
    v_lshlrev_b32 v6, 8, v6
    v_and_b32 v7, 15, v1
    v_lshl_add_u32 v6, v7, 4, v6
    v_add_u32 v15, 65536, v6
    v_add_u32 v6, s66, v15
    v_add_u32 v7, s66, v2
    v_mov_b32 v72, 0
    v_mov_b32 v73, 0
    v_mov_b32 v74, 0
    v_mov_b32 v75, 0
    v_mov_b32 v76, 0
    v_mov_b32 v77, 0
    v_mov_b32 v78, 0
    v_mov_b32 v79, 0
    v_mov_b32 v80, 0
    v_mov_b32 v81, 0
    v_mov_b32 v82, 0
    v_mov_b32 v83, 0
    v_mov_b32 v84, 0
    v_mov_b32 v85, 0
    v_mov_b32 v86, 0
    v_mov_b32 v87, 0
    v_mov_b32 v68, 0
    v_mov_b32 v69, 0
    v_mov_b32 v70, 0
    v_mov_b32 v71, 0
    s_mov_b32 s8, s16
    s_mov_b32 s9, s17
    s_mov_b32 s10, 0
    s_mov_b32 s11, 0x00020000
    s_and_b32 s31, s2, 1
    s_mul_i32 s31, s31, 1835008
    s_lshr_b32 s32, s2, 3
    s_mul_i32 s32, s32, 73728
    s_add_u32 s31, s31, s32
    s_lshl_b32 s32, s20, 10
    s_add_u32 s31, s31, s32
    s_add_u32 s67, s31, 10436608
    s_lshr_b32 s31, s2, 3
    s_lshl_b32 s31, s31, 14
    s_add_u32 s31, s31, s32
    s_add_u32 s12, s31, 13107200
    s_mul_i32 s13, s2, 37888
    s_add_u32 s13, s13, 17825792
    s_add_u32 s14, s13, 36864
    s_lshl_b32 s32, s20, 10
    s_add_u32 s13, s13, s32
    s_lshl_b32 s30, s64, 12
    s_add_u32 s30, s30, 131072
    v_mov_b32 v12, 0
    s_xor_b32 s31, s64, 0
    s_lshl_b32 s31, s31, 10
    v_add_u32 v112, s31, v7
    v_add_u32 v120, s31, v6
    s_xor_b32 s31, s64, 1
    s_lshl_b32 s31, s31, 10
    v_add_u32 v113, s31, v7
    v_add_u32 v121, s31, v6
    s_xor_b32 s31, s64, 2
    s_lshl_b32 s31, s31, 10
    v_add_u32 v114, s31, v7
    v_add_u32 v122, s31, v6
    s_xor_b32 s31, s64, 3
    s_lshl_b32 s31, s31, 10
    v_add_u32 v115, s31, v7
    v_add_u32 v123, s31, v6
    s_xor_b32 s31, s64, 4
    s_lshl_b32 s31, s31, 10
    v_add_u32 v116, s31, v7
    v_add_u32 v124, s31, v6
    s_xor_b32 s31, s64, 5
    s_lshl_b32 s31, s31, 10
    v_add_u32 v117, s31, v7
    v_add_u32 v125, s31, v6
    s_xor_b32 s31, s64, 6
    s_lshl_b32 s31, s31, 10
    v_add_u32 v118, s31, v7
    v_add_u32 v126, s31, v6
    s_xor_b32 s31, s64, 7
    s_lshl_b32 s31, s31, 10
    v_add_u32 v119, s31, v7
    v_add_u32 v127, s31, v6
    s_waitcnt vmcnt(2)
    v_max_f32_dpp v5, v5, v5 row_shr:1 row_mask:0xf bank_mask:0xf bound_ctrl:0
    v_dot2c_f32_bf16 v12, v8, v8
    s_nop 0
    v_max_f32_dpp v5, v5, v5 row_shr:2 row_mask:0xf bank_mask:0xf bound_ctrl:0
    v_dot2c_f32_bf16 v12, v9, v9
    s_nop 0
    v_max_f32_dpp v5, v5, v5 row_shr:4 row_mask:0xf bank_mask:0xf bound_ctrl:0
    v_dot2c_f32_bf16 v12, v10, v10
    s_nop 0
    v_max_f32_dpp v5, v5, v5 row_shr:8 row_mask:0xf bank_mask:0xf bound_ctrl:0
    v_dot2c_f32_bf16 v12, v11, v11
    s_nop 0
    v_max_f32_dpp v5, v5, v5 row_bcast:15 row_mask:0xa bank_mask:0xf
    s_nop 1
    v_max_f32_dpp v5, v5, v5 row_bcast:31 row_mask:0xc bank_mask:0xf
    v_mov_b32 v13, v12
    v_readlane_b32 s33, v5, 63
    s_nop 0
    v_permlane32_swap_b32 v12, v13
    v_add_f32 v12, v12, v13
    v_mul_f32 v12, s33, v12
    v_sqrt_f32 v12, v12
    s_nop 0
    v_mul_f32 v16, 0xbf8147ae, v12
    v_mov_b32 v17, v16
    v_mov_b32 v18, v16
    v_mov_b32 v19, v16
    v_mov_b32 v20, v16
    v_mov_b32 v21, v16
    v_mov_b32 v22, v16
    v_mov_b32 v23, v16
    v_mov_b32 v24, v16
    v_mov_b32 v25, v16
    v_mov_b32 v26, v16
    v_mov_b32 v27, v16
    v_mov_b32 v28, v16
    v_mov_b32 v29, v16
    v_mov_b32 v30, v16
    v_mov_b32 v31, v16
    s_waitcnt vmcnt(0)
    s_mov_b32 s63, 1
    ds_read_b128 v[88:91], v112
    s_mov_b64 exec, s[60:61]
    ds_read_b128 v[96:99], v120 offset:0
    ds_read_b128 v[100:103], v120 offset:512
    s_mov_b64 exec, -1
    s_waitcnt lgkmcnt(2)
    v_mfma_f32_32x32x16_bf16 v[32:47], v[88:91], v[8:11], v[16:31]
    s_setprio 0
    s_nop 10
    v_exp_f32 v32, v32
    v_exp_f32 v33, v33
    v_exp_f32 v34, v34
    v_cvt_pk_bf16_f32 v64, v32, v33
    v_exp_f32 v35, v35
    v_exp_f32 v36, v36
    v_cvt_pk_bf16_f32 v65, v34, v35
    v_exp_f32 v37, v37
    v_exp_f32 v38, v38
    v_cvt_pk_bf16_f32 v66, v36, v37
    v_exp_f32 v39, v39
    v_exp_f32 v40, v40
    v_cvt_pk_bf16_f32 v67, v38, v39
    v_exp_f32 v41, v41
    v_exp_f32 v42, v42
    s_waitcnt lgkmcnt(0)
    v_mfma_f32_32x32x16_bf16 v[72:87], v[96:99], v[64:67], v[72:87]
    v_cvt_pk_bf16_f32 v68, v40, v41
    v_exp_f32 v43, v43
    v_exp_f32 v44, v44
    v_cvt_pk_bf16_f32 v69, v42, v43
    v_exp_f32 v45, v45
    v_exp_f32 v46, v46
    v_exp_f32 v47, v47
    v_cvt_pk_bf16_f32 v70, v44, v45
    v_cvt_pk_bf16_f32 v71, v46, v47
    s_barrier
    s_setprio 3
    ds_read_b128 v[92:95], v113
    ds_read_b128 v[88:91], v114
    s_mov_b64 exec, s[60:61]
    ds_read_b128 v[104:107], v121 offset:0
    ds_read_b128 v[108:111], v121 offset:512
    s_mov_b64 exec, -1
    s_add_u32 m0, s24, 8192
    s_mov_b32 s29, 2105344
    buffer_load_dwordx4 v3, s[16:19], s29 offen lds
    s_add_u32 m0, s24, 73728
    s_mov_b32 s29, 4202496
    buffer_load_dwordx4 v3, s[16:19], s29 offen lds
    s_waitcnt lgkmcnt(3)
    v_mfma_f32_32x32x16_bf16 v[48:63], v[92:95], v[8:11], v[16:31]
    s_nop 7
    s_waitcnt lgkmcnt(0)
    v_mfma_f32_32x32x16_bf16 v[32:47], v[88:91], v[8:11], v[16:31]
    ds_read_b128 v[92:95], v115
    s_nop 0
    v_exp_f32 v48, v48
    v_exp_f32 v49, v49
    v_exp_f32 v50, v50
    v_cvt_pk_bf16_f32 v64, v48, v49
    v_exp_f32 v51, v51
    v_mfma_f32_32x32x16_bf16 v[72:87], v[100:103], v[68:71], v[72:87]
    s_mov_b64 exec, s[60:61]
    ds_read_b128 v[96:99], v122 offset:0
    ds_read_b128 v[100:103], v122 offset:512
    s_mov_b64 exec, -1
    v_exp_f32 v52, v52
    v_cvt_pk_bf16_f32 v65, v50, v51
    v_exp_f32 v53, v53
    v_exp_f32 v54, v54
    v_cvt_pk_bf16_f32 v66, v52, v53
    v_exp_f32 v55, v55
    v_exp_f32 v56, v56
    v_cvt_pk_bf16_f32 v67, v54, v55
    v_exp_f32 v57, v57
    v_exp_f32 v58, v58
    v_mfma_f32_32x32x16_bf16 v[72:87], v[104:107], v[64:67], v[72:87]
    s_add_u32 m0, s24, 16384
    s_mov_b32 s29, 2113536
    buffer_load_dwordx4 v3, s[16:19], s29 offen lds
    s_add_u32 m0, s24, 81920
    s_mov_b32 s29, 4210688
    buffer_load_dwordx4 v3, s[16:19], s29 offen lds
    v_cvt_pk_bf16_f32 v68, v56, v57
    v_exp_f32 v59, v59
    v_exp_f32 v60, v60
    v_cvt_pk_bf16_f32 v69, v58, v59
    v_exp_f32 v61, v61
    v_exp_f32 v62, v62
    v_exp_f32 v63, v63
    v_cvt_pk_bf16_f32 v70, v60, v61
    v_cvt_pk_bf16_f32 v71, v62, v63
    s_waitcnt lgkmcnt(0)
    v_mfma_f32_32x32x16_bf16 v[48:63], v[92:95], v[8:11], v[16:31]
    ds_read_b128 v[88:91], v116
    v_exp_f32 v32, v32
    v_exp_f32 v33, v33
    v_exp_f32 v34, v34
    v_cvt_pk_bf16_f32 v64, v32, v33
    v_exp_f32 v35, v35
    v_mfma_f32_32x32x16_bf16 v[72:87], v[108:111], v[68:71], v[72:87]
    s_mov_b64 exec, s[60:61]
    ds_read_b128 v[104:107], v123 offset:0
    ds_read_b128 v[108:111], v123 offset:512
    s_mov_b64 exec, -1
    v_exp_f32 v36, v36
    v_cvt_pk_bf16_f32 v65, v34, v35
    v_exp_f32 v37, v37
    v_exp_f32 v38, v38
    v_cvt_pk_bf16_f32 v66, v36, v37
    v_exp_f32 v39, v39
    v_exp_f32 v40, v40
    v_cvt_pk_bf16_f32 v67, v38, v39
    v_exp_f32 v41, v41
    v_exp_f32 v42, v42
    v_mfma_f32_32x32x16_bf16 v[72:87], v[96:99], v[64:67], v[72:87]
    s_add_u32 m0, s24, 24576
    s_mov_b32 s29, 2121728
    buffer_load_dwordx4 v3, s[16:19], s29 offen lds
    s_add_u32 m0, s24, 90112
    s_mov_b32 s29, 4218880
    buffer_load_dwordx4 v3, s[16:19], s29 offen lds
    s_setprio 2
    v_cvt_pk_bf16_f32 v68, v40, v41
    v_exp_f32 v43, v43
    v_exp_f32 v44, v44
    v_cvt_pk_bf16_f32 v69, v42, v43
    v_exp_f32 v45, v45
    v_exp_f32 v46, v46
    v_exp_f32 v47, v47
    v_cvt_pk_bf16_f32 v70, v44, v45
    v_cvt_pk_bf16_f32 v71, v46, v47
    s_waitcnt lgkmcnt(0)
    v_mfma_f32_32x32x16_bf16 v[32:47], v[88:91], v[8:11], v[16:31]
    ds_read_b128 v[92:95], v117
    v_exp_f32 v48, v48
    v_exp_f32 v49, v49
    v_exp_f32 v50, v50
    v_cvt_pk_bf16_f32 v64, v48, v49
    v_exp_f32 v51, v51
    v_mfma_f32_32x32x16_bf16 v[72:87], v[100:103], v[68:71], v[72:87]
    s_mov_b64 exec, s[60:61]
    ds_read_b128 v[96:99], v124 offset:0
    ds_read_b128 v[100:103], v124 offset:512
    s_mov_b64 exec, -1
    v_exp_f32 v52, v52
    v_cvt_pk_bf16_f32 v65, v50, v51
    v_exp_f32 v53, v53
    v_exp_f32 v54, v54
    v_cvt_pk_bf16_f32 v66, v52, v53
    v_exp_f32 v55, v55
    v_exp_f32 v56, v56
    v_cvt_pk_bf16_f32 v67, v54, v55
    v_exp_f32 v57, v57
    v_exp_f32 v58, v58
    v_mfma_f32_32x32x16_bf16 v[72:87], v[104:107], v[64:67], v[72:87]
    s_setprio 1
    v_cvt_pk_bf16_f32 v68, v56, v57
    v_exp_f32 v59, v59
    v_exp_f32 v60, v60
    v_cvt_pk_bf16_f32 v69, v58, v59
    v_exp_f32 v61, v61
    v_exp_f32 v62, v62
    v_exp_f32 v63, v63
    v_cvt_pk_bf16_f32 v70, v60, v61
    v_cvt_pk_bf16_f32 v71, v62, v63
    s_waitcnt lgkmcnt(0)
    v_mfma_f32_32x32x16_bf16 v[48:63], v[92:95], v[8:11], v[16:31]
    ds_read_b128 v[88:91], v118
    v_exp_f32 v32, v32
    v_exp_f32 v33, v33
    v_exp_f32 v34, v34
    v_cvt_pk_bf16_f32 v64, v32, v33
    v_exp_f32 v35, v35
    v_mfma_f32_32x32x16_bf16 v[72:87], v[108:111], v[68:71], v[72:87]
    s_mov_b64 exec, s[60:61]
    ds_read_b128 v[104:107], v125 offset:0
    ds_read_b128 v[108:111], v125 offset:512
    s_mov_b64 exec, -1
    v_exp_f32 v36, v36
    v_cvt_pk_bf16_f32 v65, v34, v35
    v_exp_f32 v37, v37
    v_exp_f32 v38, v38
    v_cvt_pk_bf16_f32 v66, v36, v37
    v_exp_f32 v39, v39
    v_exp_f32 v40, v40
    v_cvt_pk_bf16_f32 v67, v38, v39
    v_exp_f32 v41, v41
    v_exp_f32 v42, v42
    v_mfma_f32_32x32x16_bf16 v[72:87], v[96:99], v[64:67], v[72:87]
    s_setprio 0
    v_cvt_pk_bf16_f32 v68, v40, v41
    v_exp_f32 v43, v43
    v_exp_f32 v44, v44
    v_cvt_pk_bf16_f32 v69, v42, v43
    v_exp_f32 v45, v45
    v_exp_f32 v46, v46
    v_exp_f32 v47, v47
    v_cvt_pk_bf16_f32 v70, v44, v45
    v_cvt_pk_bf16_f32 v71, v46, v47
    s_waitcnt lgkmcnt(0)
    v_mfma_f32_32x32x16_bf16 v[32:47], v[88:91], v[8:11], v[16:31]
    ds_read_b128 v[92:95], v119
    v_exp_f32 v48, v48
    v_exp_f32 v49, v49
    v_exp_f32 v50, v50
    v_cvt_pk_bf16_f32 v64, v48, v49
    v_exp_f32 v51, v51
    v_mfma_f32_32x32x16_bf16 v[72:87], v[100:103], v[68:71], v[72:87]
    s_mov_b64 exec, s[60:61]
    ds_read_b128 v[96:99], v126 offset:0
    ds_read_b128 v[100:103], v126 offset:512
    s_mov_b64 exec, -1
    v_exp_f32 v52, v52
    v_cvt_pk_bf16_f32 v65, v50, v51
    v_exp_f32 v53, v53
    v_exp_f32 v54, v54
    v_cvt_pk_bf16_f32 v66, v52, v53
    v_exp_f32 v55, v55
    v_exp_f32 v56, v56
    v_cvt_pk_bf16_f32 v67, v54, v55
    v_exp_f32 v57, v57
    v_exp_f32 v58, v58
    v_mfma_f32_32x32x16_bf16 v[72:87], v[104:107], v[64:67], v[72:87]
    v_cvt_pk_bf16_f32 v68, v56, v57
    v_exp_f32 v59, v59
    v_exp_f32 v60, v60
    v_cvt_pk_bf16_f32 v69, v58, v59
    v_exp_f32 v61, v61
    v_exp_f32 v62, v62
    v_exp_f32 v63, v63
    v_cvt_pk_bf16_f32 v70, v60, v61
    v_cvt_pk_bf16_f32 v71, v62, v63
    s_waitcnt lgkmcnt(0)
    v_mfma_f32_32x32x16_bf16 v[48:63], v[92:95], v[8:11], v[16:31]
    s_waitcnt vmcnt(0)
    s_barrier
    s_setprio 3
    s_branch L_k2_prepld
L_k2_prepld_back:
    ds_read_b128 v[88:91], v7 offset:8192
    v_exp_f32 v32, v32
    v_exp_f32 v33, v33
    v_exp_f32 v34, v34
    v_cvt_pk_bf16_f32 v64, v32, v33
    v_exp_f32 v35, v35
    v_mfma_f32_32x32x16_bf16 v[72:87], v[108:111], v[68:71], v[72:87]
    s_mov_b64 exec, s[60:61]
    ds_read_b128 v[104:107], v127 offset:0
    ds_read_b128 v[108:111], v127 offset:512
    s_mov_b64 exec, -1
    v_exp_f32 v36, v36
    v_cvt_pk_bf16_f32 v65, v34, v35
    v_exp_f32 v37, v37
    v_exp_f32 v38, v38
    v_cvt_pk_bf16_f32 v66, v36, v37
    v_exp_f32 v39, v39
    v_exp_f32 v40, v40
    v_cvt_pk_bf16_f32 v67, v38, v39
    v_exp_f32 v41, v41
    v_exp_f32 v42, v42
    v_mfma_f32_32x32x16_bf16 v[72:87], v[96:99], v[64:67], v[72:87]
    v_cvt_pk_bf16_f32 v68, v40, v41
    v_exp_f32 v43, v43
    v_exp_f32 v44, v44
    v_cvt_pk_bf16_f32 v69, v42, v43
    v_exp_f32 v45, v45
    v_exp_f32 v46, v46
    v_exp_f32 v47, v47
    v_cvt_pk_bf16_f32 v70, v44, v45
    v_cvt_pk_bf16_f32 v71, v46, v47
    s_waitcnt lgkmcnt(0)
    v_mfma_f32_32x32x16_bf16 v[32:47], v[88:91], v[8:11], v[16:31]
    ds_read_b128 v[92:95], v7 offset:9216
    v_exp_f32 v48, v48
    v_exp_f32 v49, v49
    v_exp_f32 v50, v50
    v_cvt_pk_bf16_f32 v64, v48, v49
    v_exp_f32 v51, v51
    v_mfma_f32_32x32x16_bf16 v[72:87], v[100:103], v[68:71], v[72:87]
    s_mov_b64 exec, s[60:61]
    ds_read_b128 v[96:99], v6 offset:8192
    ds_read_b128 v[100:103], v6 offset:8704
    s_mov_b64 exec, -1
    v_exp_f32 v52, v52
    v_cvt_pk_bf16_f32 v65, v50, v51
    v_exp_f32 v53, v53
    v_exp_f32 v54, v54
    v_cvt_pk_bf16_f32 v66, v52, v53
    v_exp_f32 v55, v55
    v_exp_f32 v56, v56
    v_cvt_pk_bf16_f32 v67, v54, v55
    v_exp_f32 v57, v57
    v_exp_f32 v58, v58
    v_mfma_f32_32x32x16_bf16 v[72:87], v[104:107], v[64:67], v[72:87]
    v_cvt_pk_bf16_f32 v68, v56, v57
    v_exp_f32 v59, v59
    v_exp_f32 v60, v60
    v_cvt_pk_bf16_f32 v69, v58, v59
    v_exp_f32 v61, v61
    v_exp_f32 v62, v62
    v_exp_f32 v63, v63
    v_cvt_pk_bf16_f32 v70, v60, v61
    v_add_u32 v7, 8192, v7
    v_add_u32 v6, 8192, v6
    v_cvt_pk_bf16_f32 v71, v62, v63
    v_mov_b32 v120, -1
    v_mov_b32 v121, -1
    v_mov_b32 v122, -1
    v_mov_b32 v123, -1
L_k2_loop:
    s_waitcnt lgkmcnt(0)
    v_mfma_f32_32x32x16_bf16 v[48:63], v[92:95], v[8:11], v[16:31]
    ds_read_b128 v[88:91], v7 offset:2048
    v_exp_f32 v32, v32
    v_exp_f32 v33, v33
    v_exp_f32 v34, v34
    v_cvt_pk_bf16_f32 v64, v32, v33
    v_exp_f32 v35, v35
    v_mfma_f32_32x32x16_bf16 v[72:87], v[108:111], v[68:71], v[72:87]
    s_mov_b64 exec, s[60:61]
    ds_read_b128 v[104:107], v6 offset:1024
    ds_read_b128 v[108:111], v6 offset:1536
    s_mov_b64 exec, -1
    v_exp_f32 v36, v36
    v_cvt_pk_bf16_f32 v65, v34, v35
    v_exp_f32 v37, v37
    v_exp_f32 v38, v38
    v_cvt_pk_bf16_f32 v66, v36, v37
    v_exp_f32 v39, v39
    v_exp_f32 v40, v40
    v_cvt_pk_bf16_f32 v67, v38, v39
    v_exp_f32 v41, v41
    v_exp_f32 v42, v42
    v_mfma_f32_32x32x16_bf16 v[72:87], v[96:99], v[64:67], v[72:87]
    v_cvt_pk_bf16_f32 v68, v40, v41
    v_exp_f32 v43, v43
    v_exp_f32 v44, v44
    v_cvt_pk_bf16_f32 v69, v42, v43
    v_exp_f32 v45, v45
    v_exp_f32 v46, v46
    v_exp_f32 v47, v47
    v_cvt_pk_bf16_f32 v70, v44, v45
    v_cvt_pk_bf16_f32 v71, v46, v47
    s_waitcnt lgkmcnt(0)
    v_mfma_f32_32x32x16_bf16 v[32:47], v[88:91], v[8:11], v[16:31]
    ds_read_b128 v[92:95], v7 offset:3072
    v_exp_f32 v48, v48
    v_exp_f32 v49, v49
    v_exp_f32 v50, v50
    v_cvt_pk_bf16_f32 v64, v48, v49
    v_exp_f32 v51, v51
    v_mfma_f32_32x32x16_bf16 v[72:87], v[100:103], v[68:71], v[72:87]
    s_mov_b64 exec, s[60:61]
    ds_read_b128 v[96:99], v6 offset:2048
    ds_read_b128 v[100:103], v6 offset:2560
    s_mov_b64 exec, -1
    v_exp_f32 v52, v52
    v_cvt_pk_bf16_f32 v65, v50, v51
    v_exp_f32 v53, v53
    v_exp_f32 v54, v54
    v_cvt_pk_bf16_f32 v66, v52, v53
    v_exp_f32 v55, v55
    v_exp_f32 v56, v56
    v_cvt_pk_bf16_f32 v67, v54, v55
    v_exp_f32 v57, v57
    v_exp_f32 v58, v58
    v_mfma_f32_32x32x16_bf16 v[72:87], v[104:107], v[64:67], v[72:87]
    buffer_load_dwordx4 v[124:127], v2, s[8:11], s67 offen
    s_add_u32 s67, s67, 16384
    v_cvt_pk_bf16_f32 v68, v56, v57
    v_exp_f32 v59, v59
    v_exp_f32 v60, v60
    v_cvt_pk_bf16_f32 v69, v58, v59
    v_exp_f32 v61, v61
    v_exp_f32 v62, v62
    v_exp_f32 v63, v63
    v_cvt_pk_bf16_f32 v70, v60, v61
    v_cvt_pk_bf16_f32 v71, v62, v63
    s_waitcnt lgkmcnt(0)
    v_mfma_f32_32x32x16_bf16 v[48:63], v[92:95], v[8:11], v[16:31]
    ds_read_b128 v[88:91], v7 offset:4096
    v_exp_f32 v32, v32
    v_exp_f32 v33, v33
    v_exp_f32 v34, v34
    v_cvt_pk_bf16_f32 v64, v32, v33
    v_exp_f32 v35, v35
    v_mfma_f32_32x32x16_bf16 v[72:87], v[108:111], v[68:71], v[72:87]
    s_mov_b64 exec, s[60:61]
    ds_read_b128 v[104:107], v6 offset:3072
    ds_read_b128 v[108:111], v6 offset:3584
    s_mov_b64 exec, -1
    v_exp_f32 v36, v36
    v_cvt_pk_bf16_f32 v65, v34, v35
    v_exp_f32 v37, v37
    v_exp_f32 v38, v38
    v_cvt_pk_bf16_f32 v66, v36, v37
    v_exp_f32 v39, v39
    v_exp_f32 v40, v40
    v_cvt_pk_bf16_f32 v67, v38, v39
    v_exp_f32 v41, v41
    v_exp_f32 v42, v42
    v_mfma_f32_32x32x16_bf16 v[72:87], v[96:99], v[64:67], v[72:87]
    buffer_store_dwordx4 v[120:123], v2, s[16:19], s13 offen sc1
    s_add_u32 s13, s13, 16384
    s_min_u32 s13, s13, s14
    s_cmp_eq_u32 s63, 3
    s_cbranch_scc0 L_k2_p3
    s_setprio 1
L_k2_p3:
    v_cvt_pk_bf16_f32 v68, v40, v41
    v_exp_f32 v43, v43
    v_exp_f32 v44, v44
    v_cvt_pk_bf16_f32 v69, v42, v43
    v_exp_f32 v45, v45
    v_exp_f32 v46, v46
    v_exp_f32 v47, v47
    v_cvt_pk_bf16_f32 v70, v44, v45
    v_cvt_pk_bf16_f32 v71, v46, v47
    s_waitcnt lgkmcnt(0)
    v_mfma_f32_32x32x16_bf16 v[32:47], v[88:91], v[8:11], v[16:31]
    ds_read_b128 v[92:95], v7 offset:5120
    v_exp_f32 v48, v48
    v_exp_f32 v49, v49
    v_exp_f32 v50, v50
    v_cvt_pk_bf16_f32 v64, v48, v49
    v_exp_f32 v51, v51
    v_mfma_f32_32x32x16_bf16 v[72:87], v[100:103], v[68:71], v[72:87]
    s_mov_b64 exec, s[60:61]
    ds_read_b128 v[96:99], v6 offset:4096
    ds_read_b128 v[100:103], v6 offset:4608
    s_mov_b64 exec, -1
    v_exp_f32 v52, v52
    v_cvt_pk_bf16_f32 v65, v50, v51
    v_exp_f32 v53, v53
    v_exp_f32 v54, v54
    v_cvt_pk_bf16_f32 v66, v52, v53
    v_exp_f32 v55, v55
    v_exp_f32 v56, v56
    v_cvt_pk_bf16_f32 v67, v54, v55
    v_exp_f32 v57, v57
    v_exp_f32 v58, v58
    v_mfma_f32_32x32x16_bf16 v[72:87], v[104:107], v[64:67], v[72:87]
    buffer_load_dwordx4 v[124:127], v2, s[8:11], s67 offen
    s_add_u32 s67, s67, 16384
    v_cvt_pk_bf16_f32 v68, v56, v57
    v_exp_f32 v59, v59
    v_exp_f32 v60, v60
    v_cvt_pk_bf16_f32 v69, v58, v59
    v_exp_f32 v61, v61
    v_exp_f32 v62, v62
    v_exp_f32 v63, v63
    v_cvt_pk_bf16_f32 v70, v60, v61
    v_cvt_pk_bf16_f32 v71, v62, v63
    s_waitcnt lgkmcnt(0)
    v_mfma_f32_32x32x16_bf16 v[48:63], v[92:95], v[8:11], v[16:31]
    ds_read_b128 v[88:91], v7 offset:6144
    v_exp_f32 v32, v32
    v_exp_f32 v33, v33
    v_exp_f32 v34, v34
    v_cvt_pk_bf16_f32 v64, v32, v33
    v_exp_f32 v35, v35
    v_mfma_f32_32x32x16_bf16 v[72:87], v[108:111], v[68:71], v[72:87]
    s_mov_b64 exec, s[60:61]
    ds_read_b128 v[104:107], v6 offset:5120
    ds_read_b128 v[108:111], v6 offset:5632
    s_mov_b64 exec, -1
    v_exp_f32 v36, v36
    v_cvt_pk_bf16_f32 v65, v34, v35
    v_exp_f32 v37, v37
    v_exp_f32 v38, v38
    v_cvt_pk_bf16_f32 v66, v36, v37
    v_exp_f32 v39, v39
    v_exp_f32 v40, v40
    v_cvt_pk_bf16_f32 v67, v38, v39
    v_exp_f32 v41, v41
    v_exp_f32 v42, v42
    v_mfma_f32_32x32x16_bf16 v[72:87], v[96:99], v[64:67], v[72:87]
    v_cvt_pk_bf16_f32 v68, v40, v41
    v_exp_f32 v43, v43
    v_exp_f32 v44, v44
    v_cvt_pk_bf16_f32 v69, v42, v43
    v_exp_f32 v45, v45
    v_exp_f32 v46, v46
    v_exp_f32 v47, v47
    v_cvt_pk_bf16_f32 v70, v44, v45
    v_cvt_pk_bf16_f32 v71, v46, v47
    s_waitcnt lgkmcnt(0)
    v_mfma_f32_32x32x16_bf16 v[32:47], v[88:91], v[8:11], v[16:31]
    ds_read_b128 v[92:95], v7 offset:7168
    v_exp_f32 v48, v48
    v_exp_f32 v49, v49
    v_exp_f32 v50, v50
    v_cvt_pk_bf16_f32 v64, v48, v49
    v_exp_f32 v51, v51
    v_mfma_f32_32x32x16_bf16 v[72:87], v[100:103], v[68:71], v[72:87]
    s_mov_b64 exec, s[60:61]
    ds_read_b128 v[96:99], v6 offset:6144
    ds_read_b128 v[100:103], v6 offset:6656
    s_mov_b64 exec, -1
    v_exp_f32 v52, v52
    v_cvt_pk_bf16_f32 v65, v50, v51
    v_exp_f32 v53, v53
    v_exp_f32 v54, v54
    v_cvt_pk_bf16_f32 v66, v52, v53
    v_exp_f32 v55, v55
    v_exp_f32 v56, v56
    v_cvt_pk_bf16_f32 v67, v54, v55
    v_exp_f32 v57, v57
    v_exp_f32 v58, v58
    v_mfma_f32_32x32x16_bf16 v[72:87], v[104:107], v[64:67], v[72:87]
    buffer_load_dwordx4 v[124:127], v2, s[8:11], s67 offen
    s_add_u32 s67, s67, 16384
    v_cvt_pk_bf16_f32 v68, v56, v57
    v_exp_f32 v59, v59
    v_exp_f32 v60, v60
    v_cvt_pk_bf16_f32 v69, v58, v59
    v_exp_f32 v61, v61
    v_exp_f32 v62, v62
    v_exp_f32 v63, v63
    v_cvt_pk_bf16_f32 v70, v60, v61
    v_cvt_pk_bf16_f32 v71, v62, v63
    s_waitcnt lgkmcnt(0)
    v_mfma_f32_32x32x16_bf16 v[48:63], v[92:95], v[8:11], v[16:31]
    s_branch L_k2_sync
L_k2_sync_back:
    ds_read_b128 v[88:91], v7 offset:8192
    v_exp_f32 v32, v32
    v_exp_f32 v33, v33
    v_exp_f32 v34, v34
    v_cvt_pk_bf16_f32 v64, v32, v33
    v_exp_f32 v35, v35
    v_mfma_f32_32x32x16_bf16 v[72:87], v[108:111], v[68:71], v[72:87]
    s_mov_b64 exec, s[60:61]
    ds_read_b128 v[104:107], v6 offset:7168
    ds_read_b128 v[108:111], v6 offset:7680
    s_mov_b64 exec, -1
    v_exp_f32 v36, v36
    v_cvt_pk_bf16_f32 v65, v34, v35
    v_exp_f32 v37, v37
    v_exp_f32 v38, v38
    v_cvt_pk_bf16_f32 v66, v36, v37
    v_exp_f32 v39, v39
    v_exp_f32 v40, v40
    v_cvt_pk_bf16_f32 v67, v38, v39
    v_exp_f32 v41, v41
    v_exp_f32 v42, v42
    v_mfma_f32_32x32x16_bf16 v[72:87], v[96:99], v[64:67], v[72:87]
    v_cvt_pk_bf16_f32 v68, v40, v41
    v_exp_f32 v43, v43
    v_exp_f32 v44, v44
    v_cvt_pk_bf16_f32 v69, v42, v43
    v_exp_f32 v45, v45
    v_exp_f32 v46, v46
    v_exp_f32 v47, v47
    v_cvt_pk_bf16_f32 v70, v44, v45
    v_cvt_pk_bf16_f32 v71, v46, v47
    s_waitcnt lgkmcnt(0)
    v_mfma_f32_32x32x16_bf16 v[32:47], v[88:91], v[8:11], v[16:31]
    ds_read_b128 v[92:95], v7 offset:9216
    v_exp_f32 v48, v48
    v_exp_f32 v49, v49
    v_exp_f32 v50, v50
    v_cvt_pk_bf16_f32 v64, v48, v49
    v_exp_f32 v51, v51
    v_mfma_f32_32x32x16_bf16 v[72:87], v[100:103], v[68:71], v[72:87]
    s_mov_b64 exec, s[60:61]
    ds_read_b128 v[96:99], v6 offset:8192
    ds_read_b128 v[100:103], v6 offset:8704
    s_mov_b64 exec, -1
    v_exp_f32 v52, v52
    v_cvt_pk_bf16_f32 v65, v50, v51
    v_exp_f32 v53, v53
    v_exp_f32 v54, v54
    v_cvt_pk_bf16_f32 v66, v52, v53
    v_exp_f32 v55, v55
    v_exp_f32 v56, v56
    v_cvt_pk_bf16_f32 v67, v54, v55
    v_exp_f32 v57, v57
    v_exp_f32 v58, v58
    v_mfma_f32_32x32x16_bf16 v[72:87], v[104:107], v[64:67], v[72:87]
    v_cvt_pk_bf16_f32 v68, v56, v57
    v_exp_f32 v59, v59
    v_exp_f32 v60, v60
    v_cvt_pk_bf16_f32 v69, v58, v59
    v_exp_f32 v61, v61
    v_exp_f32 v62, v62
    v_exp_f32 v63, v63
    v_cvt_pk_bf16_f32 v70, v60, v61
    v_add_u32 v7, 8192, v7
    v_add_u32 v6, 8192, v6
    s_add_u32 s63, s63, 1
    v_cvt_pk_bf16_f32 v71, v62, v63
    s_cmp_lt_u32 s63, 4
    s_cbranch_scc1 L_k2_loop
    s_nop 0
    v_mfma_f32_32x32x16_bf16 v[72:87], v[108:111], v[68:71], v[72:87]
    v_add_u32 v12, s30, v2
    s_cmp_lg_u32 s65, 0
    s_cbranch_scc1 L_k2_low
    s_nop 15
    ds_write_b128 v12, v[72:75] offset:0
    ds_write_b128 v12, v[76:79] offset:1024
    ds_write_b128 v12, v[80:83] offset:2048
    s_waitcnt lgkmcnt(0)
    s_barrier
    s_cmp_ge_u32 s2, 112
    s_cbranch_scc1 L_k2_hi_end
    s_cmp_ge_u32 s20, 2
    s_cbranch_scc1 L_k2_hi_end
    s_lshl_b32 s31, s20, 8
    s_add_u32 s31, s31, 134144
    v_lshlrev_b32 v13, 2, v1
    v_add_u32 v13, s31, v13
    ds_read_b32 v32, v13 offset:0
    ds_read_b32 v33, v13 offset:4096
    ds_read_b32 v34, v13 offset:8192
    ds_read_b32 v35, v13 offset:12288
    ds_read_b32 v36, v13 offset:16384
    ds_read_b32 v37, v13 offset:20480
    ds_read_b32 v38, v13 offset:24576
    ds_read_b32 v39, v13 offset:28672
    s_lshr_b32 s31, s2, 2
    s_lshl_b32 s31, s31, 11
    s_lshl_b32 s32, s20, 10
    s_add_u32 s31, s31, s32
    s_and_b32 s32, s2, 3
    s_lshl_b32 s32, s32, 2
    s_add_u32 s31, s31, s32
    s_add_u32 s31, s31, 8388608
    s_waitcnt lgkmcnt(0)
    v_add_f32 v32, v32, v36
    v_add_f32 v33, v33, v37
    v_add_f32 v34, v34, v38
    v_add_f32 v35, v35, v39
    v_add_f32 v32, v32, v34
    v_add_f32 v33, v33, v35
    v_add_f32 v32, v32, v33
    buffer_store_dword v32, v2, s[16:19], s31 offen
    s_branch L_k2_hi_end
L_k2_low:
    s_lshl_b32 s29, s26, 15
    s_lshl_b32 s31, s21, 10
    s_add_u32 s29, s29, s31
    s_add_u32 s29, s29, 6291456
    s_barrier
    ds_read_b128 v[120:123], v12 offset:2048
    ds_read_b128 v[112:115], v12 offset:0
    ds_read_b128 v[116:119], v12 offset:1024
    s_nop 3
    s_waitcnt lgkmcnt(0)
    v_add_f32 v80, v80, v120
    v_add_f32 v79, v79, v119
    v_add_f32 v78, v78, v118
    v_add_f32 v77, v77, v117
    v_add_f32 v76, v76, v116
    v_add_f32 v75, v75, v115
    v_add_f32 v74, v74, v114
    v_add_f32 v73, v73, v113
    v_add_f32 v72, v72, v112
    v_cmp_nle_f32 vcc, 0x1f800000, v80
    v_rcp_f32 v12, v80
    s_nop 3
    s_cbranch_vccnz L_k2_fallback
L_k2_fin:
    v_mul_f32 v72, v72, v12
    v_mul_f32 v73, v73, v12
    v_mul_f32 v74, v74, v12
    v_mul_f32 v75, v75, v12
    v_mul_f32 v76, v76, v12
    v_mul_f32 v77, v77, v12
    v_mul_f32 v78, v78, v12
    v_mul_f32 v79, v79, v12
    v_cvt_pk_bf16_f32 v64, v72, v73
    v_cvt_pk_bf16_f32 v65, v74, v75
    v_cvt_pk_bf16_f32 v66, v76, v77
    v_cvt_pk_bf16_f32 v67, v78, v79
    buffer_store_dwordx4 v[64:67], v2, s[16:19], s29 offen sc1
L_k2_hi_end:
L_k2_end:
    s_endpgm
L_k2_prepld:
    s_cmp_lg_u32 s65, 0
    s_cbranch_scc1 L_k2_prepld_back
    s_sub_u32 s38, s2, 72
    s_cmp_ge_u32 s2, 184
    s_cselect_b32 s38, s38, s2
    s_cmp_ge_u32 s2, 112
    s_cbranch_scc1 L_k2_prep_plain
    s_lshr_b32 s31, s2, 2
    s_and_b32 s32, s2, 3
    s_lshl_b32 s32, s32, 3
    s_add_u32 s32, s32, s64
    s_mul_i32 s33, s32, 57344
    s_lshl_b32 s34, s31, 7
    s_add_u32 s68, s33, s34
    s_add_u32 s69, s68, 28672
    s_mov_b32 s70, s68
    s_mov_b32 s71, s69
    s_mov_b32 s39, 3584
    s_mov_b32 s48, s44
    s_mov_b32 s49, s45
    s_mov_b32 s50, 1835008
    s_mov_b32 s51, 0x00020000
    s_mov_b32 s52, s46
    s_mov_b32 s53, s47
    s_mov_b32 s54, 1835008
    s_mov_b32 s55, 0x00020000
    s_mov_b32 s35, 11
    s_mov_b32 s36, 32
    s_mov_b32 s37, 64
    s_mov_b32 s62, 96
    s_lshl_b32 s33, s31, 17
    s_lshl_b32 s34, s32, 10
    s_add_u32 s33, s33, s34
    s_add_u32 s56, s33, 10485760
    s_cmp_ge_u32 s31, 14
    s_cselect_b32 s33, 524288, 0
    s_add_u32 s56, s56, s33
    s_add_u32 s57, s56, 32768
    s_add_u32 s58, s56, 65536
    s_add_u32 s59, s56, 98304
    s_branch L_k2_prep_done
L_k2_prep_plain:
    s_cmp_ge_u32 s38, 128
    s_cselect_b32 s48, s42, s40
    s_cselect_b32 s49, s43, s41
    s_mov_b32 s50, 524288
    s_cselect_b32 s50, 1835008, s50
    s_mov_b32 s51, 0x00020000
    s_mov_b32 s52, s48
    s_mov_b32 s53, s49
    s_mov_b32 s54, s50
    s_mov_b32 s55, 0x00020000
    s_mov_b32 s31, 112
    s_cselect_b32 s31, 128, s31
    s_mov_b32 s35, 14680064
    s_mov_b32 s36, 12320768
    s_cselect_b32 s35, s35, s36
    s_cselect_b32 s36, 112, 32
    s_sub_u32 s31, s38, s31
    s_and_b32 s32, s31, 7
    s_lshr_b32 s31, s31, 3
    s_lshl_b32 s31, s31, 4
    s_lshl_b32 s33, s64, 1
    s_add_u32 s31, s31, s33
    s_lshl_b32 s33, s31, 14
    s_lshl_b32 s34, s32, 7
    s_add_u32 s68, s33, s34
    s_add_u32 s69, s68, 8192
    s_add_u32 s70, s68, 16384
    s_add_u32 s71, s68, 24576
    s_mov_b32 s39, 1024
    s_cmp_ge_u32 s38, 128
    s_cbranch_scc0 L_k2_prep_wo
    s_add_u32 s33, s31, 0
    s_mul_i32 s34, s33, 147
    s_lshr_b32 s34, s34, 10
    s_mul_i32 s36, s34, 7
    s_sub_u32 s33, s33, s36
    s_lshl_b32 s33, s33, 18
    s_lshl_b32 s34, s34, 10
    s_add_u32 s33, s33, s34
    s_lshl_b32 s34, s32, 15
    s_add_u32 s33, s33, s34
    s_add_u32 s56, s33, 14680064
    s_add_u32 s57, s56, 16384
    s_add_u32 s33, s31, 1
    s_mul_i32 s34, s33, 147
    s_lshr_b32 s34, s34, 10
    s_mul_i32 s36, s34, 7
    s_sub_u32 s33, s33, s36
    s_lshl_b32 s33, s33, 18
    s_lshl_b32 s34, s34, 10
    s_add_u32 s33, s33, s34
    s_lshl_b32 s34, s32, 15
    s_add_u32 s33, s33, s34
    s_add_u32 s58, s33, 14680064
    s_add_u32 s59, s58, 16384
    s_branch L_k2_prep_pl2
L_k2_prep_wo:
    s_lshl_b32 s32, s32, 1
    s_mul_i32 s32, s32, s36
    s_add_u32 s32, s32, s31
    s_lshl_b32 s32, s32, 10
    s_add_u32 s56, s35, s32
    s_lshl_b32 s36, s36, 10
    s_add_u32 s57, s56, s36
    s_add_u32 s58, s56, 1024
    s_add_u32 s59, s57, 1024
L_k2_prep_pl2:
    s_mov_b32 s35, 5
    s_mov_b32 s36, 64
    s_mov_b32 s37, 2048
    s_mov_b32 s62, 2112
L_k2_prep_done:
    v_lshrrev_b32 v12, 3, v1
    v_mul_lo_u32 v12, v12, s39
    v_and_b32 v13, 7, v1
    v_lshl_add_u32 v12, v13, 4, v12
    s_add_u32 m0, s30, 0
    s_nop 0
    buffer_load_dwordx4 v12, s[48:51], s68 offen lds
    s_add_u32 m0, s30, 1024
    s_nop 0
    buffer_load_dwordx4 v12, s[48:51], s69 offen lds
    s_add_u32 m0, s30, 2048
    s_nop 0
    buffer_load_dwordx4 v12, s[52:55], s70 offen lds
    s_add_u32 m0, s30, 3072
    s_nop 0
    buffer_load_dwordx4 v12, s[52:55], s71 offen lds
    s_branch L_k2_prepld_back
L_k2_sync:
    s_cmp_eq_u32 s63, 2
    s_cbranch_scc1 L_k2_pref
    s_cmp_eq_u32 s63, 3
    s_cbranch_scc1 L_k2_last
    s_setprio 2
    s_mov_b32 s10, 0x10000000
    s_cmp_lg_u32 s65, 0
    s_cbranch_scc1 L_k2_sync_back
    v_bfe_u32 v12, v1, 2, 2
    v_lshrrev_b32 v13, 5, v1
    v_lshl_add_u32 v12, v13, 2, v12
    v_lshlrev_b32 v12, 7, v12
    v_and_b32 v13, 3, v1
    v_lshl_add_u32 v12, v13, 3, v12
    v_bfe_u32 v13, v1, 4, 1
    v_lshlrev_b32 v13, s35, v13
    v_add3_u32 v12, v12, v13, s30
    v_add_u32 v13, s36, v12
    v_add_u32 v14, s37, v12
    v_add_u32 v5, s62, v12
    s_waitcnt vmcnt(0)
    ds_read_b64_tr_b16 v[112:113], v12 offset:0
    ds_read_b64_tr_b16 v[114:115], v12 offset:1024
    ds_read_b64_tr_b16 v[116:117], v13 offset:0
    ds_read_b64_tr_b16 v[118:119], v13 offset:1024
    ds_read_b64_tr_b16 v[120:121], v14 offset:0
    ds_read_b64_tr_b16 v[122:123], v14 offset:1024
    ds_read_b64_tr_b16 v[124:125], v5 offset:0
    ds_read_b64_tr_b16 v[126:127], v5 offset:1024
    s_waitcnt lgkmcnt(6)
    buffer_store_dwordx4 v[112:115], v2, s[16:19], s56 offen sc1
    s_waitcnt lgkmcnt(4)
    buffer_store_dwordx4 v[116:119], v2, s[16:19], s57 offen sc1
    s_waitcnt lgkmcnt(2)
    buffer_store_dwordx4 v[120:123], v2, s[16:19], s58 offen sc1
    s_waitcnt lgkmcnt(0)
    buffer_store_dwordx4 v[124:127], v2, s[16:19], s59 offen sc1
    s_cmp_ge_u32 s2, 112
    s_cbranch_scc1 L_k2_nocs
    v_mov_b32 v5, 0x3f803f80
    v_mov_b32 v12, 0
    v_mov_b32 v13, 0
    v_mov_b32 v14, 0
    v_mov_b32 v4, 0
    v_dot2c_f32_bf16 v12, v112, v5
    v_dot2c_f32_bf16 v13, v116, v5
    v_dot2c_f32_bf16 v14, v120, v5
    v_dot2c_f32_bf16 v4, v124, v5
    v_dot2c_f32_bf16 v12, v113, v5
    v_dot2c_f32_bf16 v13, v117, v5
    v_dot2c_f32_bf16 v14, v121, v5
    v_dot2c_f32_bf16 v4, v125, v5
    v_dot2c_f32_bf16 v12, v114, v5
    v_dot2c_f32_bf16 v13, v118, v5
    v_dot2c_f32_bf16 v14, v122, v5
    v_dot2c_f32_bf16 v4, v126, v5
    v_dot2c_f32_bf16 v12, v115, v5
    v_dot2c_f32_bf16 v13, v119, v5
    v_dot2c_f32_bf16 v14, v123, v5
    v_dot2c_f32_bf16 v4, v127, v5
    s_nop 0
    v_permlane32_swap_b32 v12, v13
    s_nop 0
    v_permlane32_swap_b32 v14, v4
    v_add_f32 v12, v12, v13
    v_add_f32 v14, v14, v4
    v_lshlrev_b32 v13, 2, v1
    v_add_u32 v13, s30, v13
    ds_write_b32 v13, v12 offset:3072
    ds_write_b32 v13, v14 offset:3328
    v_mov_b32 v120, -1
    v_mov_b32 v121, -1
    v_mov_b32 v122, -1
    v_mov_b32 v123, -1
    s_branch L_k2_sync_back
L_k2_nocs:
    s_nop 4
    v_mov_b32 v120, -1
    v_mov_b32 v121, -1
    v_mov_b32 v122, -1
    v_mov_b32 v123, -1
    s_branch L_k2_sync_back
L_k2_pref:
    s_setprio 2
    s_branch L_k2_sync_back
L_k2_last:
    s_cmp_ge_u32 s2, 16
    s_cbranch_scc1 L_k2_nocpf
    s_getpc_b64 s[48:49]
L_pf1:
    s_add_u32 s48, s48, k4_ffn_kernel-L_pf1
    s_addc_u32 s49, s49, 0
    s_mov_b32 s50, L_code_end-k4_ffn_kernel
    s_mov_b32 s51, 0x00020000
    s_mul_i32 s32, s20, 1024
    buffer_load_dwordx4 v[124:127], v2, s[48:51], s32 offen offset:0
L_k2_nocpf:
    s_setprio 0
    s_branch L_k2_sync_back
L_k2_fallback:
    v_mov_b32 v7, v2
    v_mov_b32 v12, 0xff800000
    s_mov_b32 s63, 0
L_k2_fb_loop:
    ds_read_b128 v[88:91], v7
    v_add_u32 v7, 1024, v7
    s_waitcnt lgkmcnt(0)
    v_mfma_f32_32x32x16_bf16 v[32:47], v[88:91], v[8:11], 0
    s_nop 11
    v_max3_f32 v12, v12, v32, v33
    v_max3_f32 v12, v12, v34, v35
    v_max3_f32 v12, v12, v36, v37
    v_max3_f32 v12, v12, v38, v39
    v_max3_f32 v12, v12, v40, v41
    v_max3_f32 v12, v12, v42, v43
    v_max3_f32 v12, v12, v44, v45
    v_max3_f32 v12, v12, v46, v47
    s_add_u32 s63, s63, 1
    s_cmp_lt_u32 s63, 64
    s_cbranch_scc1 L_k2_fb_loop
    v_mov_b32 v13, v12
    s_nop 1
    v_permlane32_swap_b32 v12, v13
    v_max_f32 v12, v12, v13
    v_sub_f32 v12, 0, v12
    v_mov_b32 v16, v12
    v_mov_b32 v17, v12
    v_mov_b32 v18, v12
    v_mov_b32 v19, v12
    v_mov_b32 v20, v12
    v_mov_b32 v21, v12
    v_mov_b32 v22, v12
    v_mov_b32 v23, v12
    v_mov_b32 v24, v12
    v_mov_b32 v25, v12
    v_mov_b32 v26, v12
    v_mov_b32 v27, v12
    v_mov_b32 v28, v12
    v_mov_b32 v29, v12
    v_mov_b32 v30, v12
    v_mov_b32 v31, v12
    v_mov_b32 v72, 0
    v_mov_b32 v73, 0
    v_mov_b32 v74, 0
    v_mov_b32 v75, 0
    v_mov_b32 v76, 0
    v_mov_b32 v77, 0
    v_mov_b32 v78, 0
    v_mov_b32 v79, 0
    v_mov_b32 v80, 0
    v_mov_b32 v81, 0
    v_mov_b32 v82, 0
    v_mov_b32 v83, 0
    v_mov_b32 v84, 0
    v_mov_b32 v85, 0
    v_mov_b32 v86, 0
    v_mov_b32 v87, 0
    v_mov_b32 v7, v2
    v_mov_b32 v6, v15
    s_mov_b32 s63, 0
L_k2_fb2_loop:
    ds_read_b128 v[88:91], v7
    s_mov_b64 exec, s[60:61]
    ds_read_b128 v[96:99], v6 offset:0
    ds_read_b128 v[100:103], v6 offset:512
    s_mov_b64 exec, -1
    v_add_u32 v7, 1024, v7
    v_add_u32 v6, 1024, v6
    s_waitcnt lgkmcnt(0)
    v_mfma_f32_32x32x16_bf16 v[32:47], v[88:91], v[8:11], v[16:31]
    s_nop 11
    v_exp_f32 v32, v32
    v_exp_f32 v33, v33
    v_exp_f32 v34, v34
    v_exp_f32 v35, v35
    v_exp_f32 v36, v36
    v_exp_f32 v37, v37
    v_exp_f32 v38, v38
    v_exp_f32 v39, v39
    v_exp_f32 v40, v40
    v_exp_f32 v41, v41
    v_exp_f32 v42, v42
    v_exp_f32 v43, v43
    v_exp_f32 v44, v44
    v_exp_f32 v45, v45
    v_exp_f32 v46, v46
    v_exp_f32 v47, v47
    v_cvt_pk_bf16_f32 v64, v32, v33
    v_cvt_pk_bf16_f32 v65, v34, v35
    v_cvt_pk_bf16_f32 v66, v36, v37
    v_cvt_pk_bf16_f32 v67, v38, v39
    v_cvt_pk_bf16_f32 v68, v40, v41
    v_cvt_pk_bf16_f32 v69, v42, v43
    v_cvt_pk_bf16_f32 v70, v44, v45
    v_cvt_pk_bf16_f32 v71, v46, v47
    v_mfma_f32_32x32x16_bf16 v[72:87], v[96:99], v[64:67], v[72:87]
    s_nop 0
    v_mfma_f32_32x32x16_bf16 v[72:87], v[100:103], v[68:71], v[72:87]
    s_add_u32 s63, s63, 1
    s_cmp_lt_u32 s63, 64
    s_cbranch_scc1 L_k2_fb2_loop
    s_nop 15
    v_rcp_f32 v12, v80
    s_nop 1
    s_branch L_k2_fin
.globl k4_ffn_kernel
.p2align 8
.type k4_ffn_kernel,@function
k4_ffn_kernel:
    s_cmp_ge_u32 s2, 256
    s_cbranch_scc1 L_k4_end
    s_load_dwordx2 s[16:17], s[0:1], 72
    s_load_dwordx2 s[8:9], s[0:1], 56
    s_load_dwordx2 s[12:13], s[0:1], 0
    v_and_b32 v1, 63, v0
    v_lshrrev_b32 v2, 6, v0
    s_mov_b32 s18, 0x10000000
    s_mov_b32 s19, 0x00020000
    v_readfirstlane_b32 s20, v2
    v_lshlrev_b32 v2, 4, v1
    s_lshr_b32 s33, s2, 3
    s_and_b32 s21, s2, 6
    s_lshl_b32 s21, s21, 1
    s_and_b32 s34, s33, 3
    s_add_u32 s21, s21, s34
    s_and_b32 s36, s2, 1
    s_lshl_b32 s22, s36, 3
    s_lshr_b32 s35, s33, 2
    s_add_u32 s22, s22, s35
    s_lshl_b32 s48, s35, 1
    s_and_b32 s49, s20, 1
    s_add_u32 s48, s48, s49
    s_lshl_b32 s50, s21, 1
    s_add_u32 s37, s36, s50
    s_lshl_b32 s49, s37, 1
    s_lshr_b32 s50, s20, 1
    s_add_u32 s49, s49, s50
    s_lshl_b32 s50, s35, 16
    s_add_u32 s50, s50, 12320768
    s_lshl_b32 s51, s37, 16
    s_add_u32 s51, s51, 6291456
    s_cmp_ge_u32 s20, 2
    s_cselect_b32 s50, s51, s50
    s_and_b32 s51, s20, 1
    s_lshl_b32 s51, s51, 15
    s_add_u32 s50, s50, s51
    v_add_u32 v4, s50, v2
    s_lshl_b32 s38, s20, 12
    s_add_u32 s50, s35, 0
    s_and_b32 s50, s50, 7
    s_lshl_b32 s40, s50, 12
    s_add_u32 s50, s35, 1
    s_and_b32 s50, s50, 7
    s_lshl_b32 s41, s50, 12
    s_add_u32 s50, s35, 2
    s_and_b32 s50, s50, 7
    s_lshl_b32 s42, s50, 12
    s_add_u32 s50, s35, 3
    s_and_b32 s50, s50, 7
    s_lshl_b32 s43, s50, 12
    s_add_u32 s50, s35, 4
    s_and_b32 s50, s50, 7
    s_lshl_b32 s44, s50, 12
    s_add_u32 s50, s35, 5
    s_and_b32 s50, s50, 7
    s_lshl_b32 s45, s50, 12
    s_add_u32 s50, s35, 6
    s_and_b32 s50, s50, 7
    s_lshl_b32 s46, s50, 12
    s_add_u32 s50, s35, 7
    s_and_b32 s50, s50, 7
    s_lshl_b32 s47, s50, 12
    s_mov_b32 s10, 0x200000
    s_mov_b32 s11, 0x00020000
    s_mov_b32 s14, 0x200000
    s_mov_b32 s15, 0x00020000
    s_waitcnt lgkmcnt(0)
    s_add_u32 m0, s38, 8192
    s_nop 0
    buffer_load_dwordx4 v4, s[16:19], s40 offen offset:0 lds
    buffer_load_dwordx4 v4, s[16:19], s40 offen offset:1024 lds
    buffer_load_dwordx4 v4, s[16:19], s40 offen offset:2048 lds
    buffer_load_dwordx4 v4, s[16:19], s40 offen offset:3072 lds
    s_add_u32 m0, s38, 24576
    s_nop 0
    buffer_load_dwordx4 v4, s[16:19], s41 offen offset:0 lds
    buffer_load_dwordx4 v4, s[16:19], s41 offen offset:1024 lds
    buffer_load_dwordx4 v4, s[16:19], s41 offen offset:2048 lds
    buffer_load_dwordx4 v4, s[16:19], s41 offen offset:3072 lds
    v_lshrrev_b32 v8, 3, v1
    v_lshlrev_b32 v8, 10, v8
    v_and_b32 v9, 7, v1
    v_lshrrev_b32 v10, 4, v1
    v_xor_b32 v9, v9, v10
    v_lshl_add_u32 v10, v9, 4, v8
    v_xor_b32 v9, 4, v9
    v_lshl_add_u32 v11, v9, 4, v8
    s_lshl_b32 s29, s37, 16
    s_lshl_b32 s30, s20, 14
    s_add_u32 s29, s29, s30
    s_lshl_b32 s30, s35, 7
    s_add_u32 s29, s29, s30
    s_lshl_b32 s30, s20, 11
    s_add_u32 m0, s30, 139264
    s_add_u32 s32, s29, 8192
    buffer_load_dwordx4 v10, s[12:15], s29 offen lds
    s_add_u32 m0, s30, 140288
    s_nop 0
    buffer_load_dwordx4 v11, s[12:15], s32 offen lds
    s_add_u32 m0, s38, 40960
    s_nop 0
    buffer_load_dwordx4 v4, s[16:19], s42 offen offset:0 lds
    buffer_load_dwordx4 v4, s[16:19], s42 offen offset:1024 lds
    buffer_load_dwordx4 v4, s[16:19], s42 offen offset:2048 lds
    buffer_load_dwordx4 v4, s[16:19], s42 offen offset:3072 lds
    v_and_b32 v8, 31, v1
    v_bfe_u32 v9, v8, 1, 3
    s_and_b32 s30, s20, 1
    s_lshl_b32 s30, s30, 2
    v_xor_b32 v9, s30, v9
    v_lshlrev_b32 v8, 7, v8
    v_lshrrev_b32 v10, 5, v1
    v_lshl_add_u32 v8, v10, 3, v8
    s_lshr_b32 s30, s20, 1
    s_lshl_b32 s30, s30, 12
    s_add_u32 s30, s30, 139264
    v_add_u32 v8, s30, v8
    v_xor_b32 v10, 0, v9
    v_lshl_add_u32 v80, v10, 4, v8
    v_xor_b32 v10, 1, v9
    v_lshl_add_u32 v81, v10, 4, v8
    v_xor_b32 v10, 2, v9
    v_lshl_add_u32 v82, v10, 4, v8
    v_xor_b32 v10, 3, v9
    v_lshl_add_u32 v83, v10, 4, v8
    s_and_b32 s50, s20, 1
    s_lshl_b32 s50, s50, 12
    v_add_u32 v84, s50, v2
    v_add_u32 v85, 0x10000, v84
    s_lshr_b32 s50, s20, 1
    s_lshl_b32 s50, s50, 12
    s_add_u32 s50, s50, 8192
    v_add_u32 v86, s50, v2
    v_add_u32 v87, 0x10000, v86
    s_lshl_b32 s23, s21, 2
    s_add_u32 s23, s23, s20
    s_mul_i32 s25, s22, 229376
    s_lshl_b32 s26, s20, 10
    s_add_u32 s25, s25, 10485760
    s_mul_i32 s27, s36, 524288
    s_add_u32 s25, s25, s27
    s_add_u32 s25, s25, s26
    v_add_u32 v12, s25, v2
    s_mul_i32 s50, s20, 28672
    v_add_u32 v3, s50, v2
    s_lshl_b32 s50, s48, 14
    s_lshl_b32 s51, s20, 12
    s_add_u32 s50, s50, s51
    s_add_u32 s50, s50, 14680064
    v_add_u32 v13, s50, v2
    v_xor_b32 v14, 0x4000, v13
    s_add_u32 s50, s35, 0
    s_and_b32 s50, s50, 3
    s_lshl_b32 s64, s50, 10
    s_add_u32 s50, s35, 1
    s_and_b32 s50, s50, 3
    s_lshl_b32 s65, s50, 10
    s_add_u32 s50, s35, 2
    s_and_b32 s50, s50, 3
    s_lshl_b32 s66, s50, 10
    s_add_u32 s50, s35, 3
    s_and_b32 s50, s50, 3
    s_lshl_b32 s67, s50, 10
    s_add_u32 s51, s35, s34
    s_add_u32 s50, s35, 0
    s_and_b32 s50, s50, 3
    s_mul_i32 s56, s50, 7168
    s_add_u32 s60, s56, 4096
    s_add_u32 s50, s35, 1
    s_and_b32 s50, s50, 3
    s_mul_i32 s57, s50, 7168
    s_add_u32 s61, s57, 4096
    s_add_u32 s50, s35, 2
    s_and_b32 s50, s50, 3
    s_mul_i32 s58, s50, 7168
    s_add_u32 s62, s58, 4096
    s_add_u32 s50, s35, 3
    s_and_b32 s50, s50, 3
    s_mul_i32 s59, s50, 7168
    s_add_u32 s63, s59, 4096
    s_lshl_b32 s50, s49, 14
    s_lshl_b32 s51, s20, 12
    s_add_u32 s50, s50, s51
    s_add_u32 s50, s50, 17825792
    v_add_u32 v15, s50, v2
    v_xor_b32 v7, 0x4000, v15
    s_lshl_b32 s24, s23, 15
    s_add_u32 s24, s24, 25165824
    v_add_u32 v3, s24, v2
    s_lshl_b32 s52, s23, 12
    s_add_u32 s52, s52, 27262976
    s_lshl_b32 s53, s23, 14
    s_lshl_b32 s54, s22, 10
    s_add_u32 s53, s53, s54
    s_add_u32 s53, s53, 17825792
    v_mov_b32 v200, v2
    v_add_u32 v201, 0x10000, v2
    v_add_u32 v202, 0x20000, v2
    s_waitcnt vmcnt(10)
    s_barrier
    ds_read_b128 v[128:131], v84 offset:8192
    ds_read_b128 v[132:135], v86 offset:8192
    ds_read_b128 v[136:139], v84 offset:9216
    ds_read_b128 v[140:143], v86 offset:9216
    ds_read_b128 v[144:147], v84 offset:10240
    ds_read_b128 v[148:151], v86 offset:10240
    ds_read_b128 v[152:155], v84 offset:11264
    ds_read_b128 v[156:159], v86 offset:11264
    s_add_u32 m0, s38, 57344
    s_nop 0
    buffer_load_dwordx4 v4, s[16:19], s43 offen offset:0 lds
    buffer_load_dwordx4 v4, s[16:19], s43 offen offset:1024 lds
    buffer_load_dwordx4 v4, s[16:19], s43 offen offset:2048 lds
    buffer_load_dwordx4 v4, s[16:19], s43 offen offset:3072 lds
    s_waitcnt vmcnt(10)
    s_barrier
    ds_read_b128 v[160:163], v84 offset:24576
    ds_read_b128 v[164:167], v86 offset:24576
    ds_read_b128 v[168:171], v84 offset:25600
    ds_read_b128 v[172:175], v86 offset:25600
    ds_read_b128 v[176:179], v84 offset:26624
    ds_read_b128 v[180:183], v86 offset:26624
    ds_read_b128 v[184:187], v84 offset:27648
    ds_read_b128 v[188:191], v86 offset:27648
    s_waitcnt lgkmcnt(14)
    v_mfma_f32_32x32x16_bf16 v[16:31], v[128:131], v[132:135], 0
    s_add_u32 m0, s38, 73728
    s_nop 0
    buffer_load_dwordx4 v4, s[16:19], s44 offen offset:0 lds
    s_waitcnt lgkmcnt(12)
    v_mfma_f32_32x32x16_bf16 v[16:31], v[136:139], v[140:143], v[16:31]
    buffer_load_dwordx4 v4, s[16:19], s44 offen offset:1024 lds
    s_waitcnt lgkmcnt(10)
    v_mfma_f32_32x32x16_bf16 v[16:31], v[144:147], v[148:151], v[16:31]
    buffer_load_dwordx4 v4, s[16:19], s44 offen offset:2048 lds
    s_waitcnt lgkmcnt(8)
    v_mfma_f32_32x32x16_bf16 v[16:31], v[152:155], v[156:159], v[16:31]
    buffer_load_dwordx4 v4, s[16:19], s44 offen offset:3072 lds
    s_waitcnt vmcnt(8)
    s_barrier
    ds_read_b128 v[128:131], v84 offset:40960
    ds_read_b128 v[132:135], v86 offset:40960
    ds_read_b128 v[136:139], v84 offset:41984
    ds_read_b128 v[140:143], v86 offset:41984
    ds_read_b128 v[144:147], v84 offset:43008
    ds_read_b128 v[148:151], v86 offset:43008
    ds_read_b128 v[152:155], v84 offset:44032
    ds_read_b128 v[156:159], v86 offset:44032
    s_waitcnt lgkmcnt(14)
    v_mfma_f32_32x32x16_bf16 v[16:31], v[160:163], v[164:167], v[16:31]
    s_add_u32 m0, s38, 90112
    s_nop 0
    buffer_load_dwordx4 v4, s[16:19], s45 offen offset:0 lds
    s_waitcnt lgkmcnt(12)
    v_mfma_f32_32x32x16_bf16 v[16:31], v[168:171], v[172:175], v[16:31]
    buffer_load_dwordx4 v4, s[16:19], s45 offen offset:1024 lds
    s_waitcnt lgkmcnt(10)
    v_mfma_f32_32x32x16_bf16 v[16:31], v[176:179], v[180:183], v[16:31]
    buffer_load_dwordx4 v4, s[16:19], s45 offen offset:2048 lds
    s_waitcnt lgkmcnt(8)
    v_mfma_f32_32x32x16_bf16 v[16:31], v[184:187], v[188:191], v[16:31]
    buffer_load_dwordx4 v4, s[16:19], s45 offen offset:3072 lds
    s_waitcnt vmcnt(8)
    s_barrier
    ds_read_b128 v[160:163], v84 offset:57344
    ds_read_b128 v[164:167], v86 offset:57344
    ds_read_b128 v[168:171], v84 offset:58368
    ds_read_b128 v[172:175], v86 offset:58368
    ds_read_b128 v[176:179], v84 offset:59392
    ds_read_b128 v[180:183], v86 offset:59392
    ds_read_b128 v[184:187], v84 offset:60416
    ds_read_b128 v[188:191], v86 offset:60416
    s_waitcnt lgkmcnt(14)
    v_mfma_f32_32x32x16_bf16 v[16:31], v[128:131], v[132:135], v[16:31]
    s_add_u32 m0, s38, 106496
    s_nop 0
    buffer_load_dwordx4 v4, s[16:19], s46 offen offset:0 lds
    s_waitcnt lgkmcnt(12)
    v_mfma_f32_32x32x16_bf16 v[16:31], v[136:139], v[140:143], v[16:31]
    buffer_load_dwordx4 v4, s[16:19], s46 offen offset:1024 lds
    s_waitcnt lgkmcnt(10)
    v_mfma_f32_32x32x16_bf16 v[16:31], v[144:147], v[148:151], v[16:31]
    buffer_load_dwordx4 v4, s[16:19], s46 offen offset:2048 lds
    s_waitcnt lgkmcnt(8)
    v_mfma_f32_32x32x16_bf16 v[16:31], v[152:155], v[156:159], v[16:31]
    buffer_load_dwordx4 v4, s[16:19], s46 offen offset:3072 lds
    s_waitcnt vmcnt(8)
    s_barrier
    ds_read_b128 v[128:131], v85 offset:8192
    ds_read_b128 v[132:135], v87 offset:8192
    ds_read_b128 v[136:139], v85 offset:9216
    ds_read_b128 v[140:143], v87 offset:9216
    ds_read_b128 v[144:147], v85 offset:10240
    ds_read_b128 v[148:151], v87 offset:10240
    ds_read_b128 v[152:155], v85 offset:11264
    ds_read_b128 v[156:159], v87 offset:11264
    ds_read_b64 v[96:97], v80
    ds_read_b64 v[98:99], v81
    ds_read_b64 v[100:101], v82
    ds_read_b64 v[102:103], v83
    s_waitcnt lgkmcnt(15)
    v_mfma_f32_32x32x16_bf16 v[16:31], v[160:163], v[164:167], v[16:31]
    s_add_u32 m0, s38, 122880
    s_nop 0
    buffer_load_dwordx4 v4, s[16:19], s47 offen offset:0 lds
    v_mfma_f32_32x32x16_bf16 v[16:31], v[168:171], v[172:175], v[16:31]
    buffer_load_dwordx4 v4, s[16:19], s47 offen offset:1024 lds
    s_waitcnt lgkmcnt(14)
    v_mfma_f32_32x32x16_bf16 v[16:31], v[176:179], v[180:183], v[16:31]
    buffer_load_dwordx4 v4, s[16:19], s47 offen offset:2048 lds
    s_waitcnt lgkmcnt(12)
    v_mfma_f32_32x32x16_bf16 v[16:31], v[184:187], v[188:191], v[16:31]
    buffer_load_dwordx4 v4, s[16:19], s47 offen offset:3072 lds
    s_waitcnt vmcnt(8)
    s_barrier
    ds_read_b128 v[160:163], v85 offset:24576
    ds_read_b128 v[164:167], v87 offset:24576
    ds_read_b128 v[168:171], v85 offset:25600
    ds_read_b128 v[172:175], v87 offset:25600
    ds_read_b128 v[176:179], v85 offset:26624
    ds_read_b128 v[180:183], v87 offset:26624
    ds_read_b128 v[184:187], v85 offset:27648
    ds_read_b128 v[188:191], v87 offset:27648
    s_waitcnt lgkmcnt(15)
    v_mfma_f32_32x32x16_bf16 v[16:31], v[128:131], v[132:135], v[16:31]
    v_mfma_f32_32x32x16_bf16 v[16:31], v[136:139], v[140:143], v[16:31]
    s_waitcnt lgkmcnt(14)
    v_mfma_f32_32x32x16_bf16 v[16:31], v[144:147], v[148:151], v[16:31]
    s_waitcnt lgkmcnt(12)
    v_mfma_f32_32x32x16_bf16 v[16:31], v[152:155], v[156:159], v[16:31]
    s_waitcnt vmcnt(4)
    s_barrier
    ds_read_b128 v[128:131], v85 offset:40960
    ds_read_b128 v[132:135], v87 offset:40960
    ds_read_b128 v[136:139], v85 offset:41984
    ds_read_b128 v[140:143], v87 offset:41984
    ds_read_b128 v[144:147], v85 offset:43008
    ds_read_b128 v[148:151], v87 offset:43008
    ds_read_b128 v[152:155], v85 offset:44032
    ds_read_b128 v[156:159], v87 offset:44032
    s_waitcnt lgkmcnt(14)
    v_mfma_f32_32x32x16_bf16 v[16:31], v[160:163], v[164:167], v[16:31]
    s_add_u32 m0, s26, 8192
    s_add_u32 s27, s40, 0
    buffer_load_dwordx4 v12, s[16:19], s27 offen lds
    s_waitcnt lgkmcnt(12)
    v_mfma_f32_32x32x16_bf16 v[16:31], v[168:171], v[172:175], v[16:31]
    s_add_u32 m0, s26, 12288
    s_add_u32 s27, s40, 32768
    buffer_load_dwordx4 v12, s[16:19], s27 offen lds
    s_waitcnt lgkmcnt(10)
    v_mfma_f32_32x32x16_bf16 v[16:31], v[176:179], v[180:183], v[16:31]
    s_add_u32 m0, s26, 16384
    s_add_u32 s27, s40, 65536
    buffer_load_dwordx4 v12, s[16:19], s27 offen lds
    s_waitcnt lgkmcnt(8)
    v_mfma_f32_32x32x16_bf16 v[16:31], v[184:187], v[188:191], v[16:31]
    s_add_u32 m0, s26, 20480
    s_add_u32 s27, s40, 98304
    buffer_load_dwordx4 v12, s[16:19], s27 offen lds
    v_lshlrev_b32 v112, 16, v96
    v_and_b32 v113, 0xffff0000, v96
    v_lshlrev_b32 v114, 16, v97
    v_and_b32 v115, 0xffff0000, v97
    v_lshlrev_b32 v116, 16, v98
    v_and_b32 v117, 0xffff0000, v98
    v_lshlrev_b32 v118, 16, v99
    v_and_b32 v119, 0xffff0000, v99
    v_lshlrev_b32 v120, 16, v100
    v_and_b32 v121, 0xffff0000, v100
    v_lshlrev_b32 v122, 16, v101
    v_and_b32 v123, 0xffff0000, v101
    v_lshlrev_b32 v124, 16, v102
    v_and_b32 v125, 0xffff0000, v102
    v_lshlrev_b32 v126, 16, v103
    v_and_b32 v127, 0xffff0000, v103
    s_waitcnt vmcnt(4)
    s_barrier
    ds_read_b128 v[160:163], v85 offset:57344
    ds_read_b128 v[164:167], v87 offset:57344
    ds_read_b128 v[168:171], v85 offset:58368
    ds_read_b128 v[172:175], v87 offset:58368
    ds_read_b128 v[176:179], v85 offset:59392
    ds_read_b128 v[180:183], v87 offset:59392
    ds_read_b128 v[184:187], v85 offset:60416
    ds_read_b128 v[188:191], v87 offset:60416
    s_waitcnt lgkmcnt(14)
    v_mfma_f32_32x32x16_bf16 v[16:31], v[128:131], v[132:135], v[16:31]
    s_add_u32 m0, s26, 24576
    s_add_u32 s27, s41, 0
    buffer_load_dwordx4 v12, s[16:19], s27 offen lds
    s_waitcnt lgkmcnt(12)
    v_mfma_f32_32x32x16_bf16 v[16:31], v[136:139], v[140:143], v[16:31]
    s_add_u32 m0, s26, 28672
    s_add_u32 s27, s41, 32768
    buffer_load_dwordx4 v12, s[16:19], s27 offen lds
    s_waitcnt lgkmcnt(10)
    v_mfma_f32_32x32x16_bf16 v[16:31], v[144:147], v[148:151], v[16:31]
    s_add_u32 m0, s26, 32768
    s_add_u32 s27, s41, 65536
    buffer_load_dwordx4 v12, s[16:19], s27 offen lds
    s_waitcnt lgkmcnt(8)
    v_mfma_f32_32x32x16_bf16 v[16:31], v[152:155], v[156:159], v[16:31]
    s_add_u32 m0, s26, 36864
    s_add_u32 s27, s41, 98304
    buffer_load_dwordx4 v12, s[16:19], s27 offen lds
    s_waitcnt lgkmcnt(6)
    v_mfma_f32_32x32x16_bf16 v[16:31], v[160:163], v[164:167], v[16:31]
    s_waitcnt lgkmcnt(4)
    v_mfma_f32_32x32x16_bf16 v[16:31], v[168:171], v[172:175], v[16:31]
    s_waitcnt lgkmcnt(2)
    v_mfma_f32_32x32x16_bf16 v[16:31], v[176:179], v[180:183], v[16:31]
    s_waitcnt lgkmcnt(0)
    v_mfma_f32_32x32x16_bf16 v[16:31], v[184:187], v[188:191], v[16:31]
    s_lshl_b32 s29, s49, 15
    s_lshl_b32 s30, s48, 11
    s_add_u32 s29, s29, s30
    s_add_u32 s28, s29, 25165824
    s_lshr_b32 s31, s48, 2
    s_lshl_b32 s31, s31, 10
    s_and_b32 s30, s48, 3
    s_lshl_b32 s30, s30, 2
    s_add_u32 s31, s31, s30
    s_lshl_b32 s30, s49, 12
    s_add_u32 s31, s31, s30
    s_add_u32 s31, s31, 27262976
    v_mov_b32 v104, 0
    v_mov_b32 v105, 0
    v_mov_b32 v106, 0x3f803f80
    v_add_f32 v112, v112, v16
    v_add_f32 v113, v113, v17
    v_add_f32 v114, v114, v18
    v_add_f32 v115, v115, v19
    v_add_f32 v116, v116, v20
    v_add_f32 v117, v117, v21
    v_add_f32 v118, v118, v22
    v_add_f32 v119, v119, v23
    v_cvt_pk_bf16_f32 v204, v112, v113
    v_cvt_pk_bf16_f32 v205, v114, v115
    v_cvt_pk_bf16_f32 v206, v116, v117
    v_cvt_pk_bf16_f32 v207, v118, v119
    buffer_store_dwordx4 v[204:207], v2, s[16:19], s28 offen offset:0 sc1
    v_add_f32 v120, v120, v24
    v_add_f32 v121, v121, v25
    v_add_f32 v122, v122, v26
    v_add_f32 v123, v123, v27
    v_add_f32 v124, v124, v28
    v_add_f32 v125, v125, v29
    v_add_f32 v126, v126, v30
    v_add_f32 v127, v127, v31
    v_cvt_pk_bf16_f32 v8, v120, v121
    v_cvt_pk_bf16_f32 v9, v122, v123
    v_cvt_pk_bf16_f32 v10, v124, v125
    v_cvt_pk_bf16_f32 v11, v126, v127
    buffer_store_dwordx4 v[8:11], v2, s[16:19], s28 offen offset:1024 sc1
    v_dot2c_f32_bf16 v104, v204, v106
    v_dot2c_f32_bf16 v105, v204, v204
    v_dot2c_f32_bf16 v104, v205, v106
    v_dot2c_f32_bf16 v105, v205, v205
    v_dot2c_f32_bf16 v104, v206, v106
    v_dot2c_f32_bf16 v105, v206, v206
    v_dot2c_f32_bf16 v104, v207, v106
    v_dot2c_f32_bf16 v105, v207, v207
    v_dot2c_f32_bf16 v104, v8, v106
    v_dot2c_f32_bf16 v105, v8, v8
    v_dot2c_f32_bf16 v104, v9, v106
    v_dot2c_f32_bf16 v105, v9, v9
    v_dot2c_f32_bf16 v104, v10, v106
    v_dot2c_f32_bf16 v105, v10, v10
    v_dot2c_f32_bf16 v104, v11, v106
    v_dot2c_f32_bf16 v105, v11, v11
    s_nop 2
    v_permlane32_swap_b32 v104, v105
    v_add_f32 v104, v104, v105
    buffer_store_dword v104, v2, s[16:19], s31 offen sc1
    s_add_u32 m0, s26, 40960
    s_add_u32 s27, s42, 0
    buffer_load_dwordx4 v12, s[16:19], s27 offen lds
    s_add_u32 m0, s26, 45056
    s_add_u32 s27, s42, 32768
    buffer_load_dwordx4 v12, s[16:19], s27 offen lds
    s_add_u32 m0, s26, 49152
    s_add_u32 s27, s42, 65536
    buffer_load_dwordx4 v12, s[16:19], s27 offen lds
    s_add_u32 m0, s26, 53248
    s_add_u32 s27, s42, 98304
    buffer_load_dwordx4 v12, s[16:19], s27 offen lds
    s_add_u32 m0, s26, 57344
    s_add_u32 s27, s43, 0
    buffer_load_dwordx4 v12, s[16:19], s27 offen lds
    s_add_u32 m0, s26, 61440
    s_add_u32 s27, s43, 32768
    buffer_load_dwordx4 v12, s[16:19], s27 offen lds
    s_add_u32 m0, s26, 65536
    s_add_u32 s27, s43, 65536
    buffer_load_dwordx4 v12, s[16:19], s27 offen lds
    s_add_u32 m0, s26, 69632
    s_add_u32 s27, s43, 98304
    buffer_load_dwordx4 v12, s[16:19], s27 offen lds
    s_add_u32 m0, s26, 73728
    s_add_u32 s27, s44, 0
    buffer_load_dwordx4 v12, s[16:19], s27 offen lds
    s_add_u32 m0, s26, 77824
    s_add_u32 s27, s44, 32768
    buffer_load_dwordx4 v12, s[16:19], s27 offen lds
    s_add_u32 m0, s26, 81920
    s_add_u32 s27, s44, 65536
    buffer_load_dwordx4 v12, s[16:19], s27 offen lds
    s_add_u32 m0, s26, 86016
    s_add_u32 s27, s44, 98304
    buffer_load_dwordx4 v12, s[16:19], s27 offen lds
    s_add_u32 m0, s26, 90112
    s_add_u32 s27, s45, 0
    buffer_load_dwordx4 v12, s[16:19], s27 offen lds
    s_add_u32 m0, s26, 94208
    s_add_u32 s27, s45, 32768
    buffer_load_dwordx4 v12, s[16:19], s27 offen lds
    s_add_u32 m0, s26, 98304
    s_add_u32 s27, s45, 65536
    buffer_load_dwordx4 v12, s[16:19], s27 offen lds
    s_add_u32 m0, s26, 102400
    s_add_u32 s27, s45, 98304
    buffer_load_dwordx4 v12, s[16:19], s27 offen lds
    s_mov_b32 s39, 0
    s_waitcnt vmcnt(16)
    s_add_u32 s30, s20, 4
    s_min_u32 s30, s30, 6
    s_sub_u32 s30, s30, s20
    s_mul_i32 s28, s22, 7
    s_add_u32 s28, s28, s20
    s_lshl_b32 s28, s28, 9
    s_add_u32 s28, s28, 8388608
    v_lshrrev_b32 v88, 5, v1
    v_mul_lo_u32 v88, v88, s30
    v_and_b32 v89, 31, v1
    v_lshlrev_b32 v89, 4, v89
    v_lshl_add_u32 v90, v88, 9, v89
    v_lshl_add_u32 v91, v88, 10, v89
    v_add_u32 v91, s26, v91
    buffer_load_dwordx4 a[0:3], v3, s[16:19], s40 offen offset:0 sc1
    buffer_load_dwordx4 a[4:7], v3, s[16:19], s40 offen offset:1024 sc1
    buffer_load_dwordx4 a[8:11], v3, s[16:19], s40 offen offset:2048 sc1
    buffer_load_dwordx4 a[12:15], v3, s[16:19], s40 offen offset:3072 sc1
    s_barrier
    ds_read_b128 v[128:131], v200 offset:8192
    ds_read_b128 v[132:135], v200 offset:12288
    ds_read_b128 v[136:139], v200 offset:16384
    ds_read_b128 v[140:143], v200 offset:20480
    ds_read_b128 v[144:147], v200 offset:9216
    ds_read_b128 v[148:151], v200 offset:13312
    buffer_load_dwordx4 a[16:19], v3, s[16:19], s41 offen offset:0 sc1
    buffer_load_dwordx4 a[20:23], v3, s[16:19], s41 offen offset:1024 sc1
    buffer_load_dwordx4 a[24:27], v3, s[16:19], s41 offen offset:2048 sc1
    buffer_load_dwordx4 a[28:31], v3, s[16:19], s41 offen offset:3072 sc1
    s_waitcnt vmcnt(7)
    v_accvgpr_read_b32 v4, a0
    v_accvgpr_read_b32 v5, a1
    v_accvgpr_read_b32 v6, a2
    v_accvgpr_read_b32 v0, a3
    v_max3_u32 v203, v4, v5, v6
    v_max_u32 v203, v203, v0
    v_cmp_eq_u32 vcc, -1, v203
    s_nop 3
    s_cbranch_vccnz L_rt_h0
L_ok_h0:
    s_waitcnt vmcnt(6)
    s_waitcnt lgkmcnt(4)
    v_mfma_f32_32x32x16_bf16 v[16:31], v[128:131], a[0:3], 0
    ds_read_b128 v[152:155], v200 offset:17408
    buffer_load_dwordx4 a[32:35], v3, s[16:19], s42 offen offset:0 sc1
    v_accvgpr_read_b32 v4, a4
    v_accvgpr_read_b32 v5, a5
    v_accvgpr_read_b32 v6, a6
    v_mfma_f32_32x32x16_bf16 v[32:47], v[132:135], a[0:3], 0
    ds_read_b128 v[156:159], v200 offset:21504
    buffer_load_dwordx4 a[36:39], v3, s[16:19], s42 offen offset:1024 sc1
    v_accvgpr_read_b32 v0, a7
    v_max3_u32 v203, v4, v5, v6
    v_max_u32 v203, v203, v0
    s_waitcnt lgkmcnt(4)
    v_mfma_f32_32x32x16_bf16 v[48:63], v[136:139], a[0:3], 0
    ds_read_b128 v[128:131], v200 offset:10240
    buffer_load_dwordx4 a[40:43], v3, s[16:19], s42 offen offset:2048 sc1
    v_cmp_eq_u32 vcc, -1, v203
    v_mfma_f32_32x32x16_bf16 v[64:79], v[140:143], a[0:3], 0
    ds_read_b128 v[132:135], v200 offset:14336
    s_cbranch_vccnz L_rt_h1
L_ok_h1:
    s_waitcnt vmcnt(8)
    s_waitcnt lgkmcnt(4)
    v_mfma_f32_32x32x16_bf16 v[16:31], v[144:147], a[4:7], v[16:31]
    ds_read_b128 v[136:139], v200 offset:18432
    buffer_load_dwordx4 a[44:47], v3, s[16:19], s42 offen offset:3072 sc1
    v_accvgpr_read_b32 v4, a8
    v_accvgpr_read_b32 v5, a9
    v_accvgpr_read_b32 v6, a10
    v_mfma_f32_32x32x16_bf16 v[32:47], v[148:151], a[4:7], v[32:47]
    ds_read_b128 v[140:143], v200 offset:22528
    v_accvgpr_read_b32 v0, a11
    v_max3_u32 v203, v4, v5, v6
    v_max_u32 v203, v203, v0
    s_waitcnt lgkmcnt(4)
    v_mfma_f32_32x32x16_bf16 v[48:63], v[152:155], a[4:7], v[48:63]
    ds_read_b128 v[144:147], v200 offset:11264
    buffer_load_dwordx4 a[48:51], v3, s[16:19], s43 offen offset:0 sc1
    v_cmp_eq_u32 vcc, -1, v203
    v_mfma_f32_32x32x16_bf16 v[64:79], v[156:159], a[4:7], v[64:79]
    ds_read_b128 v[148:151], v200 offset:15360
    s_cbranch_vccnz L_rt_h2
L_ok_h2:
    s_waitcnt vmcnt(9)
    s_waitcnt lgkmcnt(4)
    v_mfma_f32_32x32x16_bf16 v[16:31], v[128:131], a[8:11], v[16:31]
    ds_read_b128 v[152:155], v200 offset:19456
    buffer_load_dwordx4 a[52:55], v3, s[16:19], s43 offen offset:1024 sc1
    v_accvgpr_read_b32 v4, a12
    v_accvgpr_read_b32 v5, a13
    v_accvgpr_read_b32 v6, a14
    v_mfma_f32_32x32x16_bf16 v[32:47], v[132:135], a[8:11], v[32:47]
    ds_read_b128 v[156:159], v200 offset:23552
    v_accvgpr_read_b32 v0, a15
    v_max3_u32 v203, v4, v5, v6
    v_max_u32 v203, v203, v0
    s_waitcnt lgkmcnt(4)
    v_mfma_f32_32x32x16_bf16 v[48:63], v[136:139], a[8:11], v[48:63]
    ds_read_b128 v[128:131], v200 offset:24576
    buffer_load_dwordx4 a[56:59], v3, s[16:19], s43 offen offset:2048 sc1
    v_cmp_eq_u32 vcc, -1, v203
    v_mfma_f32_32x32x16_bf16 v[64:79], v[140:143], a[8:11], v[64:79]
    ds_read_b128 v[132:135], v200 offset:28672
    s_cbranch_vccnz L_rt_h3
L_ok_h3:
    s_waitcnt vmcnt(10)
    s_waitcnt lgkmcnt(4)
    v_mfma_f32_32x32x16_bf16 v[16:31], v[144:147], a[12:15], v[16:31]
    ds_read_b128 v[136:139], v200 offset:32768
    buffer_load_dwordx4 a[60:63], v3, s[16:19], s43 offen offset:3072 sc1
    v_accvgpr_read_b32 v4, a16
    v_accvgpr_read_b32 v5, a17
    v_accvgpr_read_b32 v6, a18
    v_mfma_f32_32x32x16_bf16 v[32:47], v[148:151], a[12:15], v[32:47]
    ds_read_b128 v[140:143], v200 offset:36864
    v_accvgpr_read_b32 v0, a19
    v_max3_u32 v203, v4, v5, v6
    v_max_u32 v203, v203, v0
    s_waitcnt lgkmcnt(4)
    v_mfma_f32_32x32x16_bf16 v[48:63], v[152:155], a[12:15], v[48:63]
    ds_read_b128 v[144:147], v200 offset:25600
    v_cmp_eq_u32 vcc, -1, v203
    v_mfma_f32_32x32x16_bf16 v[64:79], v[156:159], a[12:15], v[64:79]
    ds_read_b128 v[148:151], v200 offset:29696
    s_cbranch_vccnz L_rt_h4
L_ok_h4:
    s_waitcnt vmcnt(10)
    s_waitcnt lgkmcnt(4)
    v_mfma_f32_32x32x16_bf16 v[16:31], v[128:131], a[16:19], v[16:31]
    ds_read_b128 v[152:155], v200 offset:33792
    buffer_load_dwordx4 a[64:67], v3, s[16:19], s44 offen offset:0 sc1
    v_accvgpr_read_b32 v4, a20
    v_accvgpr_read_b32 v5, a21
    v_accvgpr_read_b32 v6, a22
    v_mfma_f32_32x32x16_bf16 v[32:47], v[132:135], a[16:19], v[32:47]
    ds_read_b128 v[156:159], v200 offset:37888
    buffer_load_dwordx4 a[68:71], v3, s[16:19], s44 offen offset:1024 sc1
    v_accvgpr_read_b32 v0, a23
    v_max3_u32 v203, v4, v5, v6
    v_max_u32 v203, v203, v0
    s_waitcnt lgkmcnt(4)
    v_mfma_f32_32x32x16_bf16 v[48:63], v[136:139], a[16:19], v[48:63]
    ds_read_b128 v[128:131], v200 offset:26624
    buffer_load_dwordx4 a[72:75], v3, s[16:19], s44 offen offset:2048 sc1
    v_cmp_eq_u32 vcc, -1, v203
    v_mfma_f32_32x32x16_bf16 v[64:79], v[140:143], a[16:19], v[64:79]
    ds_read_b128 v[132:135], v200 offset:30720
    s_cbranch_vccnz L_rt_h5
L_ok_h5:
    s_waitcnt vmcnt(12)
    s_waitcnt lgkmcnt(4)
    v_mfma_f32_32x32x16_bf16 v[16:31], v[144:147], a[20:23], v[16:31]
    ds_read_b128 v[136:139], v200 offset:34816
    buffer_load_dwordx4 a[76:79], v3, s[16:19], s44 offen offset:3072 sc1
    v_accvgpr_read_b32 v4, a24
    v_accvgpr_read_b32 v5, a25
    v_accvgpr_read_b32 v6, a26
    v_mfma_f32_32x32x16_bf16 v[32:47], v[148:151], a[20:23], v[32:47]
    ds_read_b128 v[140:143], v200 offset:38912
    v_accvgpr_read_b32 v0, a27
    v_max3_u32 v203, v4, v5, v6
    v_max_u32 v203, v203, v0
    s_waitcnt lgkmcnt(4)
    v_mfma_f32_32x32x16_bf16 v[48:63], v[152:155], a[20:23], v[48:63]
    ds_read_b128 v[144:147], v200 offset:27648
    buffer_load_dwordx4 v[176:179], v2, s[16:19], s52 offen offset:0 sc1
    v_cmp_eq_u32 vcc, -1, v203
    v_mfma_f32_32x32x16_bf16 v[64:79], v[156:159], a[20:23], v[64:79]
    ds_read_b128 v[148:151], v200 offset:31744
    s_cbranch_vccnz L_rt_h6
L_ok_h6:
    s_waitcnt vmcnt(13)
    s_waitcnt lgkmcnt(4)
    v_mfma_f32_32x32x16_bf16 v[16:31], v[128:131], a[24:27], v[16:31]
    ds_read_b128 v[152:155], v200 offset:35840
    buffer_load_dwordx4 v[180:183], v2, s[16:19], s52 offen offset:1024 sc1
    v_accvgpr_read_b32 v4, a28
    v_accvgpr_read_b32 v5, a29
    v_accvgpr_read_b32 v6, a30
    v_mfma_f32_32x32x16_bf16 v[32:47], v[132:135], a[24:27], v[32:47]
    ds_read_b128 v[156:159], v200 offset:39936
    v_accvgpr_read_b32 v0, a31
    v_max3_u32 v203, v4, v5, v6
    v_max_u32 v203, v203, v0
    s_barrier
    s_waitcnt lgkmcnt(4)
    v_mfma_f32_32x32x16_bf16 v[48:63], v[136:139], a[24:27], v[48:63]
    ds_read_b128 v[128:131], v200 offset:40960
    buffer_load_dwordx4 v[184:187], v2, s[16:19], s52 offen offset:2048 sc1
    v_cmp_eq_u32 vcc, -1, v203
    v_mfma_f32_32x32x16_bf16 v[64:79], v[140:143], a[24:27], v[64:79]
    ds_read_b128 v[132:135], v200 offset:45056
    s_cbranch_vccnz L_rt_h7
L_ok_h7:
    s_waitcnt vmcnt(14)
    s_waitcnt lgkmcnt(4)
    v_mfma_f32_32x32x16_bf16 v[16:31], v[144:147], a[28:31], v[16:31]
    ds_read_b128 v[136:139], v200 offset:49152
    buffer_load_dwordx4 v[188:191], v2, s[16:19], s52 offen offset:3072 sc1
    v_accvgpr_read_b32 v4, a32
    v_accvgpr_read_b32 v5, a33
    v_accvgpr_read_b32 v6, a34
    v_mfma_f32_32x32x16_bf16 v[32:47], v[148:151], a[28:31], v[32:47]
    ds_read_b128 v[140:143], v200 offset:53248
    v_accvgpr_read_b32 v0, a35
    v_max3_u32 v203, v4, v5, v6
    v_max_u32 v203, v203, v0
    s_waitcnt lgkmcnt(4)
    v_mfma_f32_32x32x16_bf16 v[48:63], v[152:155], a[28:31], v[48:63]
    ds_read_b128 v[144:147], v200 offset:41984
    buffer_load_dwordx4 v[80:83], v90, s[16:19], s28 offen
    v_cmp_eq_u32 vcc, -1, v203
    v_mfma_f32_32x32x16_bf16 v[64:79], v[156:159], a[28:31], v[64:79]
    ds_read_b128 v[148:151], v200 offset:46080
    s_cbranch_vccnz L_rt_h8
L_ok_h8:
    s_waitcnt vmcnt(15)
    s_waitcnt lgkmcnt(4)
    v_mfma_f32_32x32x16_bf16 v[16:31], v[128:131], a[32:35], v[16:31]
    ds_read_b128 v[152:155], v200 offset:50176
    buffer_load_dwordx4 a[80:83], v3, s[16:19], s45 offen offset:0 sc1
    v_accvgpr_read_b32 v4, a36
    v_accvgpr_read_b32 v5, a37
    v_accvgpr_read_b32 v6, a38
    v_mfma_f32_32x32x16_bf16 v[32:47], v[132:135], a[32:35], v[32:47]
    ds_read_b128 v[156:159], v200 offset:54272
    buffer_load_dwordx4 a[84:87], v3, s[16:19], s45 offen offset:1024 sc1
    v_accvgpr_read_b32 v0, a39
    v_max3_u32 v203, v4, v5, v6
    v_max_u32 v203, v203, v0
    s_waitcnt lgkmcnt(4)
    v_mfma_f32_32x32x16_bf16 v[48:63], v[136:139], a[32:35], v[48:63]
    ds_read_b128 v[128:131], v200 offset:43008
    buffer_load_dwordx4 a[88:91], v3, s[16:19], s45 offen offset:2048 sc1
    v_cmp_eq_u32 vcc, -1, v203
    v_mfma_f32_32x32x16_bf16 v[64:79], v[140:143], a[32:35], v[64:79]
    ds_read_b128 v[132:135], v200 offset:47104
    s_cbranch_vccnz L_rt_h9
L_ok_h9:
    s_waitcnt vmcnt(17)
    s_waitcnt lgkmcnt(4)
    v_mfma_f32_32x32x16_bf16 v[16:31], v[144:147], a[36:39], v[16:31]
    ds_read_b128 v[136:139], v200 offset:51200
    buffer_load_dwordx4 a[92:95], v3, s[16:19], s45 offen offset:3072 sc1
    v_accvgpr_read_b32 v4, a40
    v_accvgpr_read_b32 v5, a41
    v_accvgpr_read_b32 v6, a42
    v_mfma_f32_32x32x16_bf16 v[32:47], v[148:151], a[36:39], v[32:47]
    ds_read_b128 v[140:143], v200 offset:55296
    v_accvgpr_read_b32 v0, a43
    v_max3_u32 v203, v4, v5, v6
    v_max_u32 v203, v203, v0
    s_waitcnt lgkmcnt(4)
    v_mfma_f32_32x32x16_bf16 v[48:63], v[152:155], a[36:39], v[48:63]
    ds_read_b128 v[144:147], v200 offset:44032
    s_add_u32 m0, s26, 106496
    s_add_u32 s27, s46, 0
    buffer_load_dwordx4 v12, s[16:19], s27 offen lds
    v_cmp_eq_u32 vcc, -1, v203
    v_mfma_f32_32x32x16_bf16 v[64:79], v[156:159], a[36:39], v[64:79]
    ds_read_b128 v[148:151], v200 offset:48128
    s_cbranch_vccnz L_rt_h10
L_ok_h10:
    s_waitcnt vmcnt(18)
    s_waitcnt lgkmcnt(4)
    v_mfma_f32_32x32x16_bf16 v[16:31], v[128:131], a[40:43], v[16:31]
    ds_read_b128 v[152:155], v200 offset:52224
    s_add_u32 m0, s26, 110592
    s_add_u32 s27, s46, 32768
    buffer_load_dwordx4 v12, s[16:19], s27 offen lds
    v_accvgpr_read_b32 v4, a44
    v_accvgpr_read_b32 v5, a45
    v_accvgpr_read_b32 v6, a46
    v_mfma_f32_32x32x16_bf16 v[32:47], v[132:135], a[40:43], v[32:47]
    ds_read_b128 v[156:159], v200 offset:56320
    v_accvgpr_read_b32 v0, a47
    v_max3_u32 v203, v4, v5, v6
    v_max_u32 v203, v203, v0
    s_barrier
    s_waitcnt lgkmcnt(4)
    v_mfma_f32_32x32x16_bf16 v[48:63], v[136:139], a[40:43], v[48:63]
    ds_read_b128 v[128:131], v200 offset:57344
    s_add_u32 m0, s26, 114688
    s_add_u32 s27, s46, 65536
    buffer_load_dwordx4 v12, s[16:19], s27 offen lds
    v_cmp_eq_u32 vcc, -1, v203
    v_mfma_f32_32x32x16_bf16 v[64:79], v[140:143], a[40:43], v[64:79]
    ds_read_b128 v[132:135], v200 offset:61440
    s_cbranch_vccnz L_rt_h11
L_ok_h11:
    s_waitcnt vmcnt(19)
    s_waitcnt lgkmcnt(4)
    v_mfma_f32_32x32x16_bf16 v[16:31], v[144:147], a[44:47], v[16:31]
    ds_read_b128 v[136:139], v201 offset:0
    s_add_u32 m0, s26, 118784
    s_add_u32 s27, s46, 98304
    buffer_load_dwordx4 v12, s[16:19], s27 offen lds
    v_accvgpr_read_b32 v4, a48
    v_accvgpr_read_b32 v5, a49
    v_accvgpr_read_b32 v6, a50
    v_mfma_f32_32x32x16_bf16 v[32:47], v[148:151], a[44:47], v[32:47]
    ds_read_b128 v[140:143], v201 offset:4096
    v_accvgpr_read_b32 v0, a51
    v_max3_u32 v203, v4, v5, v6
    v_max_u32 v203, v203, v0
    s_waitcnt lgkmcnt(4)
    v_mfma_f32_32x32x16_bf16 v[48:63], v[152:155], a[44:47], v[48:63]
    ds_read_b128 v[144:147], v200 offset:58368
    v_cmp_eq_u32 vcc, -1, v203
    v_mfma_f32_32x32x16_bf16 v[64:79], v[156:159], a[44:47], v[64:79]
    ds_read_b128 v[148:151], v200 offset:62464
    s_cbranch_vccnz L_rt_h12
L_ok_h12:
    s_waitcnt vmcnt(19)
    s_waitcnt lgkmcnt(4)
    v_mfma_f32_32x32x16_bf16 v[16:31], v[128:131], a[48:51], v[16:31]
    ds_read_b128 v[152:155], v201 offset:1024
    buffer_load_dwordx4 a[96:99], v3, s[16:19], s46 offen offset:0 sc1
    v_accvgpr_read_b32 v4, a52
    v_accvgpr_read_b32 v5, a53
    v_accvgpr_read_b32 v6, a54
    v_mfma_f32_32x32x16_bf16 v[32:47], v[132:135], a[48:51], v[32:47]
    ds_read_b128 v[156:159], v201 offset:5120
    buffer_load_dwordx4 a[100:103], v3, s[16:19], s46 offen offset:1024 sc1
    v_accvgpr_read_b32 v0, a55
    v_max3_u32 v203, v4, v5, v6
    v_max_u32 v203, v203, v0
    s_waitcnt lgkmcnt(4)
    v_mfma_f32_32x32x16_bf16 v[48:63], v[136:139], a[48:51], v[48:63]
    ds_read_b128 v[128:131], v200 offset:59392
    buffer_load_dwordx4 a[104:107], v3, s[16:19], s46 offen offset:2048 sc1
    v_cmp_eq_u32 vcc, -1, v203
    v_mfma_f32_32x32x16_bf16 v[64:79], v[140:143], a[48:51], v[64:79]
    ds_read_b128 v[132:135], v200 offset:63488
    s_cbranch_vccnz L_rt_h13
L_ok_h13:
    s_waitcnt vmcnt(21)
    s_waitcnt lgkmcnt(4)
    v_mfma_f32_32x32x16_bf16 v[16:31], v[144:147], a[52:55], v[16:31]
    ds_read_b128 v[136:139], v201 offset:2048
    buffer_load_dwordx4 a[108:111], v3, s[16:19], s46 offen offset:3072 sc1
    v_accvgpr_read_b32 v4, a56
    v_accvgpr_read_b32 v5, a57
    v_accvgpr_read_b32 v6, a58
    v_mfma_f32_32x32x16_bf16 v[32:47], v[148:151], a[52:55], v[32:47]
    ds_read_b128 v[140:143], v201 offset:6144
    v_accvgpr_read_b32 v0, a59
    v_max3_u32 v203, v4, v5, v6
    v_max_u32 v203, v203, v0
    s_waitcnt lgkmcnt(4)
    v_mfma_f32_32x32x16_bf16 v[48:63], v[152:155], a[52:55], v[48:63]
    ds_read_b128 v[144:147], v200 offset:60416
    s_add_u32 m0, s26, 122880
    s_add_u32 s27, s47, 0
    buffer_load_dwordx4 v12, s[16:19], s27 offen lds
    v_cmp_eq_u32 vcc, -1, v203
    v_mfma_f32_32x32x16_bf16 v[64:79], v[156:159], a[52:55], v[64:79]
    ds_read_b128 v[148:151], v200 offset:64512
    s_cbranch_vccnz L_rt_h14
L_ok_h14:
    s_waitcnt vmcnt(22)
    s_waitcnt lgkmcnt(4)
    v_mfma_f32_32x32x16_bf16 v[16:31], v[128:131], a[56:59], v[16:31]
    ds_read_b128 v[152:155], v201 offset:3072
    s_add_u32 m0, s26, 126976
    s_add_u32 s27, s47, 32768
    buffer_load_dwordx4 v12, s[16:19], s27 offen lds
    v_accvgpr_read_b32 v4, a60
    v_accvgpr_read_b32 v5, a61
    v_accvgpr_read_b32 v6, a62
    v_mfma_f32_32x32x16_bf16 v[32:47], v[132:135], a[56:59], v[32:47]
    ds_read_b128 v[156:159], v201 offset:7168
    v_accvgpr_read_b32 v0, a63
    v_max3_u32 v203, v4, v5, v6
    v_max_u32 v203, v203, v0
    s_barrier
    s_waitcnt lgkmcnt(4)
    v_mfma_f32_32x32x16_bf16 v[48:63], v[136:139], a[56:59], v[48:63]
    ds_read_b128 v[128:131], v201 offset:8192
    s_add_u32 m0, s26, 131072
    s_add_u32 s27, s47, 65536
    buffer_load_dwordx4 v12, s[16:19], s27 offen lds
    v_cmp_eq_u32 vcc, -1, v203
    v_mfma_f32_32x32x16_bf16 v[64:79], v[140:143], a[56:59], v[64:79]
    ds_read_b128 v[132:135], v201 offset:12288
    s_cbranch_vccnz L_rt_h15
L_ok_h15:
    s_waitcnt vmcnt(23)
    s_waitcnt lgkmcnt(4)
    v_mfma_f32_32x32x16_bf16 v[16:31], v[144:147], a[60:63], v[16:31]
    ds_read_b128 v[136:139], v201 offset:16384
    s_add_u32 m0, s26, 135168
    s_add_u32 s27, s47, 98304
    buffer_load_dwordx4 v12, s[16:19], s27 offen lds
    v_accvgpr_read_b32 v4, a64
    v_accvgpr_read_b32 v5, a65
    v_accvgpr_read_b32 v6, a66
    v_mfma_f32_32x32x16_bf16 v[32:47], v[148:151], a[60:63], v[32:47]
    ds_read_b128 v[140:143], v201 offset:20480
    v_accvgpr_read_b32 v0, a67
    v_max3_u32 v203, v4, v5, v6
    v_max_u32 v203, v203, v0
    s_waitcnt lgkmcnt(4)
    v_mfma_f32_32x32x16_bf16 v[48:63], v[152:155], a[60:63], v[48:63]
    ds_read_b128 v[144:147], v201 offset:9216
    v_cmp_eq_u32 vcc, -1, v203
    v_mfma_f32_32x32x16_bf16 v[64:79], v[156:159], a[60:63], v[64:79]
    ds_read_b128 v[148:151], v201 offset:13312
    s_cbranch_vccnz L_rt_h16
L_ok_h16:
    s_waitcnt vmcnt(16)
    s_waitcnt lgkmcnt(4)
    v_mfma_f32_32x32x16_bf16 v[16:31], v[128:131], a[64:67], v[16:31]
    ds_read_b128 v[152:155], v201 offset:17408
    buffer_load_dwordx4 a[112:115], v3, s[16:19], s47 offen offset:0 sc1
    v_accvgpr_read_b32 v4, a68
    v_accvgpr_read_b32 v5, a69
    v_accvgpr_read_b32 v6, a70
    v_mfma_f32_32x32x16_bf16 v[32:47], v[132:135], a[64:67], v[32:47]
    ds_read_b128 v[156:159], v201 offset:21504
    buffer_load_dwordx4 a[116:119], v3, s[16:19], s47 offen offset:1024 sc1
    v_accvgpr_read_b32 v0, a71
    v_max3_u32 v203, v4, v5, v6
    v_max_u32 v203, v203, v0
    s_waitcnt lgkmcnt(4)
    v_mfma_f32_32x32x16_bf16 v[48:63], v[136:139], a[64:67], v[48:63]
    ds_read_b128 v[128:131], v201 offset:10240
    buffer_load_dwordx4 a[120:123], v3, s[16:19], s47 offen offset:2048 sc1
    v_cmp_eq_u32 vcc, -1, v203
    v_add_f32 v80, v80, v81
    v_add_f32 v82, v82, v83
    v_mfma_f32_32x32x16_bf16 v[64:79], v[140:143], a[64:67], v[64:79]
    ds_read_b128 v[132:135], v201 offset:14336
    s_cbranch_vccnz L_rt_h17
L_ok_h17:
    v_add_f32 v80, v80, v82
    v_and_b32 v81, 0xffff0000, v80
    v_sub_f32 v83, v80, v81
    v_and_b32 v82, 0xffff0000, v83
    s_waitcnt lgkmcnt(4)
    v_mfma_f32_32x32x16_bf16 v[16:31], v[144:147], a[68:71], v[16:31]
    ds_read_b128 v[136:139], v201 offset:18432
    buffer_load_dwordx4 a[124:127], v3, s[16:19], s47 offen offset:3072 sc1
    v_accvgpr_read_b32 v4, a72
    v_accvgpr_read_b32 v5, a73
    v_accvgpr_read_b32 v6, a74
    v_mfma_f32_32x32x16_bf16 v[32:47], v[148:151], a[68:71], v[32:47]
    ds_read_b128 v[140:143], v201 offset:22528
    v_accvgpr_read_b32 v0, a75
    v_max3_u32 v203, v4, v5, v6
    v_max_u32 v203, v203, v0
    v_sub_f32 v83, v83, v82
    s_waitcnt lgkmcnt(4)
    v_mfma_f32_32x32x16_bf16 v[48:63], v[152:155], a[68:71], v[48:63]
    ds_read_b128 v[144:147], v201 offset:11264
    s_add_u32 m0, s26, 139264
    s_add_u32 s27, s40, 131072
    buffer_load_dwordx4 v12, s[16:19], s27 offen lds
    v_cmp_eq_u32 vcc, -1, v203
    v_and_b32 v83, 0xffff0000, v83
    v_lshrrev_b32 v84, 16, v81
    v_mfma_f32_32x32x16_bf16 v[64:79], v[156:159], a[68:71], v[64:79]
    ds_read_b128 v[148:151], v201 offset:15360
    s_cbranch_vccnz L_rt_h18
L_ok_h18:
    v_or_b32 v84, v84, v81
    v_lshrrev_b32 v85, 16, v82
    v_or_b32 v85, v85, v81
    v_lshrrev_b32 v86, 16, v83
    s_waitcnt lgkmcnt(4)
    v_mfma_f32_32x32x16_bf16 v[16:31], v[128:131], a[72:75], v[16:31]
    ds_read_b128 v[152:155], v201 offset:19456
    s_add_u32 m0, s26, 143360
    s_add_u32 s27, s41, 131072
    buffer_load_dwordx4 v12, s[16:19], s27 offen lds
    v_accvgpr_read_b32 v4, a76
    v_accvgpr_read_b32 v5, a77
    v_accvgpr_read_b32 v6, a78
    v_mfma_f32_32x32x16_bf16 v[32:47], v[132:135], a[72:75], v[32:47]
    ds_read_b128 v[156:159], v201 offset:23552
    v_accvgpr_read_b32 v0, a79
    v_max3_u32 v203, v4, v5, v6
    v_max_u32 v203, v203, v0
    v_or_b32 v86, v86, v82
    s_barrier
    s_waitcnt lgkmcnt(4)
    v_mfma_f32_32x32x16_bf16 v[48:63], v[136:139], a[72:75], v[48:63]
    ds_read_b128 v[128:131], v201 offset:24576
    s_add_u32 m0, s26, 147456
    s_add_u32 s27, s42, 131072
    buffer_load_dwordx4 v12, s[16:19], s27 offen lds
    v_cmp_eq_u32 vcc, -1, v203
    v_mov_b32 v87, 0
    ds_write_b128 v91, v[84:87] offset:0
    v_mfma_f32_32x32x16_bf16 v[64:79], v[140:143], a[72:75], v[64:79]
    ds_read_b128 v[132:135], v201 offset:28672
    s_cbranch_vccnz L_rt_h19
L_ok_h19:
    v_mov_b32 v92, 0
    v_mov_b32 v93, 0
    v_mov_b32 v94, 0
    v_mov_b32 v95, 0
    s_waitcnt vmcnt(22)
    s_waitcnt lgkmcnt(5)
    v_mfma_f32_32x32x16_bf16 v[16:31], v[144:147], a[76:79], v[16:31]
    ds_read_b128 v[136:139], v201 offset:32768
    s_add_u32 m0, s26, 151552
    s_add_u32 s27, s43, 131072
    buffer_load_dwordx4 v12, s[16:19], s27 offen lds
    v_accvgpr_read_b32 v4, a80
    v_accvgpr_read_b32 v5, a81
    v_accvgpr_read_b32 v6, a82
    v_mfma_f32_32x32x16_bf16 v[32:47], v[148:151], a[76:79], v[32:47]
    ds_read_b128 v[140:143], v201 offset:36864
    v_accvgpr_read_b32 v0, a83
    v_max3_u32 v203, v4, v5, v6
    v_max_u32 v203, v203, v0
    ds_write_b128 v91, v[92:95] offset:512
    s_waitcnt lgkmcnt(6)
    v_mfma_f32_32x32x16_bf16 v[48:63], v[152:155], a[76:79], v[48:63]
    ds_read_b128 v[144:147], v201 offset:25600
    v_cmp_eq_u32 vcc, -1, v203
    v_mfma_f32_32x32x16_bf16 v[64:79], v[156:159], a[76:79], v[64:79]
    ds_read_b128 v[148:151], v201 offset:29696
    s_cbranch_vccnz L_rt_h20
L_ok_h20:
    v_max3_u32 v203, v176, v177, v178
    v_max_u32 v203, v203, v179
    v_max3_u32 v203, v203, v180, v181
    v_max3_u32 v203, v203, v182, v183
    v_max3_u32 v203, v203, v184, v185
    v_max3_u32 v203, v203, v186, v187
    v_max3_u32 v203, v203, v188, v189
    v_max3_u32 v203, v203, v190, v191
    v_cmp_eq_u32 vcc, -1, v203
    s_nop 3
    s_cbranch_vccnz L_rt_st
L_ok_st:
    s_waitcnt vmcnt(22)
    s_waitcnt lgkmcnt(5)
    v_mfma_f32_32x32x16_bf16 v[16:31], v[128:131], a[80:83], v[16:31]
    ds_read_b128 v[152:155], v201 offset:33792
    s_add_u32 m0, s26, 8192
    s_add_u32 s27, s44, 131072
    buffer_load_dwordx4 v12, s[16:19], s27 offen lds
    v_accvgpr_read_b32 v4, a84
    v_accvgpr_read_b32 v5, a85
    v_accvgpr_read_b32 v6, a86
    v_mfma_f32_32x32x16_bf16 v[32:47], v[132:135], a[80:83], v[32:47]
    ds_read_b128 v[156:159], v201 offset:37888
    v_accvgpr_read_b32 v0, a87
    v_max3_u32 v203, v4, v5, v6
    v_max_u32 v203, v203, v0
    v_add_f32 v176, v176, v184
    s_waitcnt lgkmcnt(5)
    v_mfma_f32_32x32x16_bf16 v[48:63], v[136:139], a[80:83], v[48:63]
    ds_read_b128 v[128:131], v201 offset:26624
    s_add_u32 m0, s26, 12288
    s_add_u32 s27, s45, 131072
    buffer_load_dwordx4 v12, s[16:19], s27 offen lds
    v_cmp_eq_u32 vcc, -1, v203
    v_add_f32 v177, v177, v185
    v_add_f32 v178, v178, v186
    v_mfma_f32_32x32x16_bf16 v[64:79], v[140:143], a[80:83], v[64:79]
    ds_read_b128 v[132:135], v201 offset:30720
    s_cbranch_vccnz L_rt_h21
L_ok_h21:
    v_add_f32 v179, v179, v187
    v_add_f32 v180, v180, v188
    v_add_f32 v181, v181, v189
    v_add_f32 v182, v182, v190
    s_waitcnt vmcnt(23)
    s_waitcnt lgkmcnt(4)
    v_mfma_f32_32x32x16_bf16 v[16:31], v[144:147], a[84:87], v[16:31]
    ds_read_b128 v[136:139], v201 offset:34816
    s_add_u32 m0, s26, 16384
    s_add_u32 s27, s46, 131072
    buffer_load_dwordx4 v12, s[16:19], s27 offen lds
    v_accvgpr_read_b32 v4, a88
    v_accvgpr_read_b32 v5, a89
    v_accvgpr_read_b32 v6, a90
    v_mfma_f32_32x32x16_bf16 v[32:47], v[148:151], a[84:87], v[32:47]
    ds_read_b128 v[140:143], v201 offset:38912
    v_accvgpr_read_b32 v0, a91
    v_max3_u32 v203, v4, v5, v6
    v_max_u32 v203, v203, v0
    v_add_f32 v183, v183, v191
    s_waitcnt lgkmcnt(4)
    v_mfma_f32_32x32x16_bf16 v[48:63], v[152:155], a[84:87], v[48:63]
    ds_read_b128 v[144:147], v201 offset:27648
    s_add_u32 m0, s26, 20480
    s_add_u32 s27, s47, 131072
    buffer_load_dwordx4 v12, s[16:19], s27 offen lds
    v_cmp_eq_u32 vcc, -1, v203
    v_add_f32 v176, v176, v180
    v_add_f32 v177, v177, v181
    v_mfma_f32_32x32x16_bf16 v[64:79], v[156:159], a[84:87], v[64:79]
    ds_read_b128 v[148:151], v201 offset:31744
    s_cbranch_vccnz L_rt_h22
L_ok_h22:
    v_add_f32 v178, v178, v182
    v_add_f32 v179, v179, v183
    v_add_f32 v176, v176, v178
    v_add_f32 v177, v177, v179
    s_waitcnt vmcnt(24)
    s_waitcnt lgkmcnt(4)
    v_mfma_f32_32x32x16_bf16 v[16:31], v[128:131], a[88:91], v[16:31]
    ds_read_b128 v[152:155], v201 offset:35840
    v_accvgpr_read_b32 v4, a92
    v_accvgpr_read_b32 v5, a93
    v_accvgpr_read_b32 v6, a94
    v_add_f32 v176, v176, v177
    v_mov_b32 v177, v176
    v_mfma_f32_32x32x16_bf16 v[32:47], v[132:135], a[88:91], v[32:47]
    ds_read_b128 v[156:159], v201 offset:39936
    v_accvgpr_read_b32 v0, a95
    v_max3_u32 v203, v4, v5, v6
    v_max_u32 v203, v203, v0
    v_permlane32_swap_b32 v176, v177
    s_waitcnt vmcnt(20)
    s_barrier
    s_waitcnt lgkmcnt(4)
    v_mfma_f32_32x32x16_bf16 v[48:63], v[136:139], a[88:91], v[48:63]
    ds_read_b128 v[128:131], v201 offset:40960
    v_cmp_eq_u32 vcc, -1, v203
    v_mul_f32 v196, 0xbb000000, v176
    v_mul_f32 v177, 0x3b000000, v177
    v_fma_f32 v177, -v196, v196, v177
    v_max_f32 v177, 0, v177
    v_mfma_f32_32x32x16_bf16 v[64:79], v[140:143], a[88:91], v[64:79]
    ds_read_b128 v[132:135], v201 offset:45056
    s_cbranch_vccnz L_rt_h23
L_ok_h23:
    v_add_f32 v177, 0x3727c5ac, v177
    v_rsq_f32 v197, v177
    s_waitcnt vmcnt(19)
    s_waitcnt lgkmcnt(4)
    v_mfma_f32_32x32x16_bf16 v[16:31], v[144:147], a[92:95], v[16:31]
    ds_read_b128 v[136:139], v201 offset:49152
    v_accvgpr_read_b32 v4, a96
    v_accvgpr_read_b32 v5, a97
    v_accvgpr_read_b32 v6, a98
    v_sqrt_f32 v199, v177
    v_mfma_f32_32x32x16_bf16 v[32:47], v[148:151], a[92:95], v[32:47]
    ds_read_b128 v[140:143], v201 offset:53248
    v_accvgpr_read_b32 v0, a99
    v_max3_u32 v203, v4, v5, v6
    v_max_u32 v203, v203, v0
    v_mul_f32 v198, 0xbfb8aa3b, v197
    s_waitcnt lgkmcnt(4)
    v_mfma_f32_32x32x16_bf16 v[48:63], v[152:155], a[92:95], v[48:63]
    ds_read_b128 v[144:147], v201 offset:41984
    v_cmp_eq_u32 vcc, -1, v203
    v_mul_f32 v199, 0xbfb8aa3b, v199
    v_and_b32 v160, 0xffff0000, v196
    v_sub_f32 v162, v196, v160
    v_and_b32 v161, 0xffff0000, v162
    v_mfma_f32_32x32x16_bf16 v[64:79], v[156:159], a[92:95], v[64:79]
    ds_read_b128 v[148:151], v201 offset:46080
    s_cbranch_vccnz L_rt_h24
L_ok_h24:
    v_sub_f32 v162, v162, v161
    v_and_b32 v162, 0xffff0000, v162
    v_lshrrev_b32 v192, 16, v160
    v_or_b32 v192, v192, v161
    s_waitcnt vmcnt(18)
    s_waitcnt lgkmcnt(4)
    v_mfma_f32_32x32x16_bf16 v[16:31], v[128:131], a[96:99], v[16:31]
    ds_read_b128 v[152:155], v201 offset:50176
    s_add_u32 m0, s26, 24576
    s_add_u32 s27, s40, 163840
    buffer_load_dwordx4 v12, s[16:19], s27 offen lds
    v_accvgpr_read_b32 v4, a100
    v_accvgpr_read_b32 v5, a101
    v_accvgpr_read_b32 v6, a102
    v_mfma_f32_32x32x16_bf16 v[32:47], v[132:135], a[96:99], v[32:47]
    ds_read_b128 v[156:159], v201 offset:54272
    s_add_u32 m0, s26, 28672
    s_add_u32 s27, s41, 163840
    buffer_load_dwordx4 v12, s[16:19], s27 offen lds
    v_accvgpr_read_b32 v0, a103
    v_max3_u32 v203, v4, v5, v6
    v_max_u32 v203, v203, v0
    s_waitcnt lgkmcnt(4)
    v_mfma_f32_32x32x16_bf16 v[48:63], v[136:139], a[96:99], v[48:63]
    ds_read_b128 v[128:131], v201 offset:43008
    s_add_u32 m0, s26, 32768
    s_add_u32 s27, s42, 163840
    buffer_load_dwordx4 v12, s[16:19], s27 offen lds
    v_cmp_eq_u32 vcc, -1, v203
    v_lshrrev_b32 v193, 16, v160
    v_or_b32 v193, v193, v162
    v_mfma_f32_32x32x16_bf16 v[64:79], v[140:143], a[96:99], v[64:79]
    ds_read_b128 v[132:135], v201 offset:47104
    s_cbranch_vccnz L_rt_h25
L_ok_h25:
    v_lshrrev_b32 v194, 16, v160
    v_or_b32 v194, v194, v161
    v_mov_b32 v195, 0
    s_waitcnt vmcnt(20)
    s_waitcnt lgkmcnt(4)
    v_mfma_f32_32x32x16_bf16 v[16:31], v[144:147], a[100:103], v[16:31]
    ds_read_b128 v[136:139], v201 offset:51200
    s_add_u32 m0, s26, 36864
    s_add_u32 s27, s43, 163840
    buffer_load_dwordx4 v12, s[16:19], s27 offen lds
    v_accvgpr_read_b32 v4, a104
    v_accvgpr_read_b32 v5, a105
    v_accvgpr_read_b32 v6, a106
    v_mfma_f32_32x32x16_bf16 v[32:47], v[148:151], a[100:103], v[32:47]
    ds_read_b128 v[140:143], v201 offset:55296
    v_accvgpr_read_b32 v0, a107
    v_max3_u32 v203, v4, v5, v6
    v_max_u32 v203, v203, v0
    s_waitcnt lgkmcnt(4)
    v_mfma_f32_32x32x16_bf16 v[48:63], v[152:155], a[100:103], v[48:63]
    ds_read_b128 v[144:147], v201 offset:44032
    s_add_u32 m0, s26, 40960
    s_add_u32 s27, s44, 163840
    buffer_load_dwordx4 v12, s[16:19], s27 offen lds
    v_cmp_eq_u32 vcc, -1, v203
    v_mfma_f32_32x32x16_bf16 v[64:79], v[156:159], a[100:103], v[64:79]
    ds_read_b128 v[148:151], v201 offset:48128
    s_cbranch_vccnz L_rt_h26
L_ok_h26:
    s_waitcnt vmcnt(21)
    s_waitcnt lgkmcnt(4)
    v_mfma_f32_32x32x16_bf16 v[16:31], v[128:131], a[104:107], v[16:31]
    ds_read_b128 v[152:155], v201 offset:52224
    s_add_u32 m0, s26, 45056
    s_add_u32 s27, s45, 163840
    buffer_load_dwordx4 v12, s[16:19], s27 offen lds
    v_accvgpr_read_b32 v4, a108
    v_accvgpr_read_b32 v5, a109
    v_accvgpr_read_b32 v6, a110
    v_mfma_f32_32x32x16_bf16 v[32:47], v[132:135], a[104:107], v[32:47]
    ds_read_b128 v[156:159], v201 offset:56320
    v_accvgpr_read_b32 v0, a111
    v_max3_u32 v203, v4, v5, v6
    v_max_u32 v203, v203, v0
    s_waitcnt vmcnt(18)
    s_barrier
    s_waitcnt lgkmcnt(4)
    v_mfma_f32_32x32x16_bf16 v[48:63], v[136:139], a[104:107], v[48:63]
    ds_read_b128 v[128:131], v201 offset:57344
    s_add_u32 m0, s26, 49152
    s_add_u32 s27, s46, 163840
    buffer_load_dwordx4 v12, s[16:19], s27 offen lds
    v_cmp_eq_u32 vcc, -1, v203
    v_mfma_f32_32x32x16_bf16 v[64:79], v[140:143], a[104:107], v[64:79]
    ds_read_b128 v[132:135], v201 offset:61440
    s_cbranch_vccnz L_rt_h27
L_ok_h27:
    s_waitcnt vmcnt(18)
    s_waitcnt lgkmcnt(4)
    v_mfma_f32_32x32x16_bf16 v[16:31], v[144:147], a[108:111], v[16:31]
    ds_read_b128 v[136:139], v202 offset:0
    s_add_u32 m0, s26, 53248
    s_add_u32 s27, s47, 163840
    buffer_load_dwordx4 v12, s[16:19], s27 offen lds
    v_accvgpr_read_b32 v4, a112
    v_accvgpr_read_b32 v5, a113
    v_accvgpr_read_b32 v6, a114
    v_mfma_f32_32x32x16_bf16 v[32:47], v[148:151], a[108:111], v[32:47]
    ds_read_b128 v[140:143], v202 offset:4096
    v_accvgpr_read_b32 v0, a115
    v_max3_u32 v203, v4, v5, v6
    v_max_u32 v203, v203, v0
    s_waitcnt lgkmcnt(4)
    v_mfma_f32_32x32x16_bf16 v[48:63], v[152:155], a[108:111], v[48:63]
    ds_read_b128 v[144:147], v201 offset:58368
    v_cmp_eq_u32 vcc, -1, v203
    v_mfma_f32_32x32x16_bf16 v[64:79], v[156:159], a[108:111], v[64:79]
    ds_read_b128 v[148:151], v201 offset:62464
    s_cbranch_vccnz L_rt_h28
L_ok_h28:
    s_waitcnt vmcnt(18)
    s_waitcnt lgkmcnt(4)
    v_mfma_f32_32x32x16_bf16 v[16:31], v[128:131], a[112:115], v[16:31]
    ds_read_b128 v[152:155], v202 offset:1024
    s_add_u32 m0, s26, 57344
    s_add_u32 s27, s40, 196608
    buffer_load_dwordx4 v12, s[16:19], s27 offen lds
    v_accvgpr_read_b32 v4, a116
    v_accvgpr_read_b32 v5, a117
    v_accvgpr_read_b32 v6, a118
    v_mfma_f32_32x32x16_bf16 v[32:47], v[132:135], a[112:115], v[32:47]
    ds_read_b128 v[156:159], v202 offset:5120
    s_add_u32 m0, s26, 61440
    s_add_u32 s27, s41, 196608
    buffer_load_dwordx4 v12, s[16:19], s27 offen lds
    v_accvgpr_read_b32 v0, a119
    v_max3_u32 v203, v4, v5, v6
    v_max_u32 v203, v203, v0
    s_waitcnt lgkmcnt(4)
    v_mfma_f32_32x32x16_bf16 v[48:63], v[136:139], a[112:115], v[48:63]
    ds_read_b128 v[128:131], v201 offset:59392
    s_add_u32 m0, s26, 65536
    s_add_u32 s27, s42, 196608
    buffer_load_dwordx4 v12, s[16:19], s27 offen lds
    v_cmp_eq_u32 vcc, -1, v203
    v_mfma_f32_32x32x16_bf16 v[64:79], v[140:143], a[112:115], v[64:79]
    ds_read_b128 v[132:135], v201 offset:63488
    s_cbranch_vccnz L_rt_h29
L_ok_h29:
    s_waitcnt vmcnt(20)
    s_waitcnt lgkmcnt(4)
    v_mfma_f32_32x32x16_bf16 v[16:31], v[144:147], a[116:119], v[16:31]
    ds_read_b128 v[136:139], v202 offset:2048
    s_add_u32 m0, s26, 69632
    s_add_u32 s27, s43, 196608
    buffer_load_dwordx4 v12, s[16:19], s27 offen lds
    v_accvgpr_read_b32 v4, a120
    v_accvgpr_read_b32 v5, a121
    v_accvgpr_read_b32 v6, a122
    v_mfma_f32_32x32x16_bf16 v[32:47], v[148:151], a[116:119], v[32:47]
    ds_read_b128 v[140:143], v202 offset:6144
    v_accvgpr_read_b32 v0, a123
    v_max3_u32 v203, v4, v5, v6
    v_max_u32 v203, v203, v0
    s_waitcnt lgkmcnt(4)
    v_mfma_f32_32x32x16_bf16 v[48:63], v[152:155], a[116:119], v[48:63]
    ds_read_b128 v[144:147], v201 offset:60416
    s_add_u32 m0, s26, 73728
    s_add_u32 s27, s44, 196608
    buffer_load_dwordx4 v12, s[16:19], s27 offen lds
    v_cmp_eq_u32 vcc, -1, v203
    v_mfma_f32_32x32x16_bf16 v[64:79], v[156:159], a[116:119], v[64:79]
    ds_read_b128 v[148:151], v201 offset:64512
    s_cbranch_vccnz L_rt_h30
L_ok_h30:
    s_waitcnt vmcnt(21)
    s_waitcnt lgkmcnt(4)
    v_mfma_f32_32x32x16_bf16 v[16:31], v[128:131], a[120:123], v[16:31]
    ds_read_b128 v[152:155], v202 offset:3072
    s_add_u32 m0, s26, 77824
    s_add_u32 s27, s45, 196608
    buffer_load_dwordx4 v12, s[16:19], s27 offen lds
    v_accvgpr_read_b32 v4, a124
    v_accvgpr_read_b32 v5, a125
    v_accvgpr_read_b32 v6, a126
    v_mfma_f32_32x32x16_bf16 v[32:47], v[132:135], a[120:123], v[32:47]
    ds_read_b128 v[156:159], v202 offset:7168
    v_accvgpr_read_b32 v0, a127
    v_max3_u32 v203, v4, v5, v6
    v_max_u32 v203, v203, v0
    s_waitcnt lgkmcnt(4)
    v_mfma_f32_32x32x16_bf16 v[48:63], v[136:139], a[120:123], v[48:63]
    ds_read_b128 v[128:131], v200 offset:0
    s_add_u32 m0, s26, 81920
    s_add_u32 s27, s46, 196608
    buffer_load_dwordx4 v12, s[16:19], s27 offen lds
    v_cmp_eq_u32 vcc, -1, v203
    v_mfma_f32_32x32x16_bf16 v[64:79], v[140:143], a[120:123], v[64:79]
    ds_read_b128 v[132:135], v200 offset:1024
    s_cbranch_vccnz L_rt_h31
L_ok_h31:
    s_waitcnt lgkmcnt(4)
    v_mfma_f32_32x32x16_bf16 v[16:31], v[144:147], a[124:127], v[16:31]
    ds_read_b128 v[136:139], v200 offset:2048
    s_add_u32 m0, s26, 86016
    s_add_u32 s27, s47, 196608
    buffer_load_dwordx4 v12, s[16:19], s27 offen lds
    v_mfma_f32_32x32x16_bf16 v[32:47], v[148:151], a[124:127], v[32:47]
    ds_read_b128 v[140:143], v200 offset:3072
    s_waitcnt vmcnt(20)
    s_barrier
    s_waitcnt lgkmcnt(4)
    v_mfma_f32_32x32x16_bf16 v[48:63], v[152:155], a[124:127], v[48:63]
    ds_read_b128 v[144:147], v202 offset:8192
    s_add_u32 s68, s64, 0
    buffer_load_dwordx4 a[128:131], v13, s[16:19], s68 offen
    v_mfma_f32_32x32x16_bf16 v[64:79], v[156:159], a[124:127], v[64:79]
    ds_read_b128 v[148:151], v202 offset:9216
    s_waitcnt lgkmcnt(4)
    v_mfma_f32_32x32x16_bf16 v[16:31], v[128:131], v[192:195], v[16:31]
    ds_read_b128 v[152:155], v202 offset:10240
    buffer_load_dwordx4 a[132:135], v14, s[16:19], s68 offen
    v_mfma_f32_32x32x16_bf16 v[32:47], v[132:135], v[192:195], v[32:47]
    ds_read_b128 v[156:159], v202 offset:11264
    s_waitcnt lgkmcnt(4)
    v_mfma_f32_32x32x16_bf16 v[48:63], v[136:139], v[192:195], v[48:63]
    ds_read_b128 v[128:131], v202 offset:12288
    s_add_u32 s68, s65, 0
    buffer_load_dwordx4 a[136:139], v13, s[16:19], s68 offen
    v_mfma_f32_32x32x16_bf16 v[64:79], v[140:143], v[192:195], v[64:79]
    ds_read_b128 v[132:135], v202 offset:13312
    s_waitcnt lgkmcnt(4)
    v_mfma_f32_32x32x16_bf16 v[80:95], v[144:147], a[0:3], 0
    ds_read_b128 v[136:139], v202 offset:14336
    buffer_load_dwordx4 a[140:143], v14, s[16:19], s68 offen
    v_mul_f32 v16, v198, v16
    v_mul_f32 v17, v198, v17
    v_mul_f32 v18, v198, v18
    v_mul_f32 v19, v198, v19
    v_mfma_f32_32x32x16_bf16 v[80:95], v[148:151], a[4:7], v[80:95]
    ds_read_b128 v[140:143], v202 offset:15360
    v_mul_f32 v20, v198, v20
    v_mul_f32 v21, v198, v21
    v_mul_f32 v22, v198, v22
    v_mul_f32 v23, v198, v23
    s_waitcnt lgkmcnt(4)
    v_mfma_f32_32x32x16_bf16 v[80:95], v[152:155], a[8:11], v[80:95]
    ds_read_b128 v[144:147], v202 offset:16384
    s_add_u32 s68, s66, 0
    buffer_load_dwordx4 a[144:147], v13, s[16:19], s68 offen
    v_exp_f32 v160, v16
    v_mul_f32 v24, v16, v24
    v_mfma_f32_32x32x16_bf16 v[80:95], v[156:159], a[12:15], v[80:95]
    ds_read_b128 v[148:151], v202 offset:17408
    v_exp_f32 v161, v17
    v_mul_f32 v25, v17, v25
    s_waitcnt lgkmcnt(4)
    v_mfma_f32_32x32x16_bf16 v[80:95], v[128:131], a[16:19], v[80:95]
    ds_read_b128 v[152:155], v202 offset:18432
    buffer_load_dwordx4 a[148:151], v14, s[16:19], s68 offen
    v_exp_f32 v162, v18
    v_mul_f32 v26, v18, v26
    v_mfma_f32_32x32x16_bf16 v[80:95], v[132:135], a[20:23], v[80:95]
    ds_read_b128 v[156:159], v202 offset:19456
    v_exp_f32 v163, v19
    v_mul_f32 v27, v19, v27
    s_waitcnt lgkmcnt(4)
    v_mfma_f32_32x32x16_bf16 v[80:95], v[136:139], a[24:27], v[80:95]
    ds_read_b128 v[128:131], v202 offset:20480
    s_add_u32 s68, s67, 0
    buffer_load_dwordx4 a[152:155], v13, s[16:19], s68 offen
    v_exp_f32 v164, v20
    v_mul_f32 v28, v20, v28
    v_mfma_f32_32x32x16_bf16 v[80:95], v[140:143], a[28:31], v[80:95]
    ds_read_b128 v[132:135], v202 offset:21504
    v_exp_f32 v165, v21
    v_mul_f32 v29, v21, v29
    s_waitcnt lgkmcnt(4)
    v_mfma_f32_32x32x16_bf16 v[80:95], v[144:147], a[32:35], v[80:95]
    ds_read_b128 v[136:139], v202 offset:22528
    buffer_load_dwordx4 a[156:159], v14, s[16:19], s68 offen
    v_exp_f32 v166, v22
    v_mul_f32 v30, v22, v30
    v_mfma_f32_32x32x16_bf16 v[80:95], v[148:151], a[36:39], v[80:95]
    ds_read_b128 v[140:143], v202 offset:23552
    v_exp_f32 v167, v23
    v_mul_f32 v31, v23, v31
    v_fma_f32 v160, v160, v199, v199
    s_waitcnt vmcnt(24)
    s_barrier
    s_waitcnt lgkmcnt(4)
    v_mfma_f32_32x32x16_bf16 v[80:95], v[152:155], a[40:43], v[80:95]
    ds_read_b128 v[144:147], v200 offset:8192
    s_add_u32 s68, s64, 262144
    buffer_load_dwordx4 a[160:163], v13, s[16:19], s68 offen
    v_fma_f32 v161, v161, v199, v199
    v_fma_f32 v162, v162, v199, v199
    v_fma_f32 v163, v163, v199, v199
    v_fma_f32 v164, v164, v199, v199
    v_mfma_f32_32x32x16_bf16 v[80:95], v[156:159], a[44:47], v[80:95]
    ds_read_b128 v[148:151], v200 offset:9216
    v_fma_f32 v165, v165, v199, v199
    v_fma_f32 v166, v166, v199, v199
    v_fma_f32 v167, v167, v199, v199
    s_waitcnt lgkmcnt(4)
    v_mfma_f32_32x32x16_bf16 v[80:95], v[128:131], a[48:51], v[80:95]
    ds_read_b128 v[152:155], v200 offset:10240
    buffer_load_dwordx4 a[164:167], v14, s[16:19], s68 offen
    v_rcp_f32 v160, v160
    v_rcp_f32 v161, v161
    v_mfma_f32_32x32x16_bf16 v[80:95], v[132:135], a[52:55], v[80:95]
    ds_read_b128 v[156:159], v200 offset:11264
    v_mul_f32 v24, v24, v160
    v_rcp_f32 v162, v162
    v_mul_f32 v25, v25, v161
    s_waitcnt lgkmcnt(4)
    v_mfma_f32_32x32x16_bf16 v[80:95], v[136:139], a[56:59], v[80:95]
    ds_read_b128 v[128:131], v200 offset:12288
    s_add_u32 s68, s65, 262144
    buffer_load_dwordx4 a[168:171], v13, s[16:19], s68 offen
    v_rcp_f32 v163, v163
    v_mul_f32 v26, v26, v162
    v_mfma_f32_32x32x16_bf16 v[80:95], v[140:143], a[60:63], v[80:95]
    ds_read_b128 v[132:135], v200 offset:13312
    v_rcp_f32 v164, v164
    v_mul_f32 v27, v27, v163
    s_waitcnt lgkmcnt(4)
    v_mfma_f32_32x32x16_bf16 v[80:95], v[144:147], a[64:67], v[80:95]
    ds_read_b128 v[136:139], v200 offset:14336
    buffer_load_dwordx4 a[172:175], v14, s[16:19], s68 offen
    v_rcp_f32 v165, v165
    v_mul_f32 v28, v28, v164
    v_mfma_f32_32x32x16_bf16 v[80:95], v[148:151], a[68:71], v[80:95]
    ds_read_b128 v[140:143], v200 offset:15360
    v_rcp_f32 v166, v166
    v_mul_f32 v29, v29, v165
    s_waitcnt lgkmcnt(4)
    v_mfma_f32_32x32x16_bf16 v[80:95], v[152:155], a[72:75], v[80:95]
    ds_read_b128 v[144:147], v200 offset:16384
    s_add_u32 s68, s66, 262144
    buffer_load_dwordx4 a[176:179], v13, s[16:19], s68 offen
    v_rcp_f32 v167, v167
    v_mul_f32 v30, v30, v166
    v_mul_f32 v31, v31, v167
    v_mfma_f32_32x32x16_bf16 v[80:95], v[156:159], a[76:79], v[80:95]
    ds_read_b128 v[148:151], v200 offset:17408
    v_cvt_pk_bf16_f32 v168, v24, v25
    v_cvt_pk_bf16_f32 v169, v26, v27
    v_cvt_pk_bf16_f32 v170, v28, v29
    s_add_u32 s54, s53, 0
    s_waitcnt lgkmcnt(4)
    v_mfma_f32_32x32x16_bf16 v[80:95], v[128:131], a[80:83], v[80:95]
    ds_read_b128 v[152:155], v200 offset:18432
    buffer_load_dwordx4 a[180:183], v14, s[16:19], s68 offen
    v_cvt_pk_bf16_f32 v171, v30, v31
    buffer_store_dwordx4 v[168:171], v2, s[16:19], s54 offen sc1
    v_mul_f32 v32, v198, v32
    v_mul_f32 v33, v198, v33
    v_mfma_f32_32x32x16_bf16 v[80:95], v[132:135], a[84:87], v[80:95]
    ds_read_b128 v[156:159], v200 offset:19456
    v_mul_f32 v34, v198, v34
    v_mul_f32 v35, v198, v35
    v_mul_f32 v36, v198, v36
    v_mul_f32 v37, v198, v37
    s_waitcnt lgkmcnt(4)
    v_mfma_f32_32x32x16_bf16 v[80:95], v[136:139], a[88:91], v[80:95]
    ds_read_b128 v[128:131], v200 offset:20480
    s_add_u32 s68, s67, 262144
    buffer_load_dwordx4 a[184:187], v13, s[16:19], s68 offen
    v_mul_f32 v38, v198, v38
    v_mul_f32 v39, v198, v39
    v_exp_f32 v160, v32
    v_mfma_f32_32x32x16_bf16 v[80:95], v[140:143], a[92:95], v[80:95]
    ds_read_b128 v[132:135], v200 offset:21504
    v_mul_f32 v40, v32, v40
    v_exp_f32 v161, v33
    v_mul_f32 v41, v33, v41
    s_waitcnt lgkmcnt(4)
    v_mfma_f32_32x32x16_bf16 v[80:95], v[144:147], a[96:99], v[80:95]
    ds_read_b128 v[136:139], v200 offset:22528
    buffer_load_dwordx4 a[188:191], v14, s[16:19], s68 offen
    v_exp_f32 v162, v34
    v_mul_f32 v42, v34, v42
    v_mfma_f32_32x32x16_bf16 v[80:95], v[148:151], a[100:103], v[80:95]
    ds_read_b128 v[140:143], v200 offset:23552
    v_exp_f32 v163, v35
    v_mul_f32 v43, v35, v43
    s_waitcnt lgkmcnt(4)
    v_mfma_f32_32x32x16_bf16 v[80:95], v[152:155], a[104:107], v[80:95]
    ds_read_b128 v[144:147], v200 offset:4096
    s_add_u32 s68, s64, 524288
    buffer_load_dwordx4 a[192:195], v13, s[16:19], s68 offen
    v_exp_f32 v164, v36
    v_mul_f32 v44, v36, v44
    s_waitcnt vmcnt(30)
    s_barrier
    v_mfma_f32_32x32x16_bf16 v[80:95], v[156:159], a[108:111], v[80:95]
    ds_read_b128 v[148:151], v200 offset:24576
    v_exp_f32 v165, v37
    v_mul_f32 v45, v37, v45
    s_waitcnt lgkmcnt(4)
    v_mfma_f32_32x32x16_bf16 v[80:95], v[128:131], a[112:115], v[80:95]
    ds_read_b128 v[152:155], v200 offset:25600
    buffer_load_dwordx4 a[196:199], v14, s[16:19], s68 offen
    v_exp_f32 v166, v38
    v_mul_f32 v46, v38, v46
    v_mfma_f32_32x32x16_bf16 v[80:95], v[132:135], a[116:119], v[80:95]
    ds_read_b128 v[156:159], v200 offset:26624
    v_exp_f32 v167, v39
    v_mul_f32 v47, v39, v47
    v_fma_f32 v160, v160, v199, v199
    s_waitcnt lgkmcnt(4)
    v_mfma_f32_32x32x16_bf16 v[80:95], v[136:139], a[120:123], v[80:95]
    ds_read_b128 v[128:131], v200 offset:27648
    s_add_u32 s68, s65, 524288
    buffer_load_dwordx4 a[200:203], v13, s[16:19], s68 offen
    v_fma_f32 v161, v161, v199, v199
    v_fma_f32 v162, v162, v199, v199
    v_fma_f32 v163, v163, v199, v199
    v_fma_f32 v164, v164, v199, v199
    v_mfma_f32_32x32x16_bf16 v[80:95], v[140:143], a[124:127], v[80:95]
    ds_read_b128 v[132:135], v200 offset:28672
    v_fma_f32 v165, v165, v199, v199
    v_fma_f32 v166, v166, v199, v199
    v_fma_f32 v167, v167, v199, v199
    s_waitcnt lgkmcnt(4)
    v_mfma_f32_32x32x16_bf16 v[80:95], v[144:147], v[192:195], v[80:95]
    ds_read_b128 v[136:139], v200 offset:29696
    buffer_load_dwordx4 a[204:207], v14, s[16:19], s68 offen
    v_rcp_f32 v160, v160
    v_rcp_f32 v161, v161
    v_mfma_f32_32x32x16_bf16 v[96:111], v[148:151], a[0:3], 0
    ds_read_b128 v[140:143], v200 offset:30720
    v_mul_f32 v40, v40, v160
    v_rcp_f32 v162, v162
    v_mul_f32 v41, v41, v161
    s_waitcnt lgkmcnt(4)
    v_mfma_f32_32x32x16_bf16 v[96:111], v[152:155], a[4:7], v[96:111]
    ds_read_b128 v[144:147], v200 offset:31744
    s_add_u32 s68, s66, 524288
    buffer_load_dwordx4 a[208:211], v13, s[16:19], s68 offen
    v_rcp_f32 v163, v163
    v_mul_f32 v42, v42, v162
    v_mfma_f32_32x32x16_bf16 v[96:111], v[156:159], a[8:11], v[96:111]
    ds_read_b128 v[148:151], v200 offset:32768
    v_rcp_f32 v164, v164
    v_mul_f32 v43, v43, v163
    s_waitcnt lgkmcnt(4)
    v_mfma_f32_32x32x16_bf16 v[96:111], v[128:131], a[12:15], v[96:111]
    ds_read_b128 v[152:155], v200 offset:33792
    buffer_load_dwordx4 a[212:215], v14, s[16:19], s68 offen
    v_rcp_f32 v165, v165
    v_mul_f32 v44, v44, v164
    v_mfma_f32_32x32x16_bf16 v[96:111], v[132:135], a[16:19], v[96:111]
    ds_read_b128 v[156:159], v200 offset:34816
    v_rcp_f32 v166, v166
    v_mul_f32 v45, v45, v165
    s_waitcnt lgkmcnt(4)
    v_mfma_f32_32x32x16_bf16 v[96:111], v[136:139], a[20:23], v[96:111]
    ds_read_b128 v[128:131], v200 offset:35840
    s_add_u32 s68, s67, 524288
    buffer_load_dwordx4 a[216:219], v13, s[16:19], s68 offen
    v_rcp_f32 v167, v167
    v_mul_f32 v46, v46, v166
    v_mul_f32 v47, v47, v167
    v_mfma_f32_32x32x16_bf16 v[96:111], v[140:143], a[24:27], v[96:111]
    ds_read_b128 v[132:135], v200 offset:36864
    v_cvt_pk_bf16_f32 v172, v40, v41
    v_cvt_pk_bf16_f32 v173, v42, v43
    v_cvt_pk_bf16_f32 v174, v44, v45
    s_add_u32 s54, s53, 1048576
    s_waitcnt lgkmcnt(4)
    v_mfma_f32_32x32x16_bf16 v[96:111], v[144:147], a[28:31], v[96:111]
    ds_read_b128 v[136:139], v200 offset:37888
    buffer_load_dwordx4 a[220:223], v14, s[16:19], s68 offen
    v_cvt_pk_bf16_f32 v175, v46, v47
    buffer_store_dwordx4 v[172:175], v2, s[16:19], s54 offen sc1
    v_mul_f32 v48, v198, v48
    v_mul_f32 v49, v198, v49
    v_mfma_f32_32x32x16_bf16 v[96:111], v[148:151], a[32:35], v[96:111]
    ds_read_b128 v[140:143], v200 offset:38912
    v_mul_f32 v50, v198, v50
    v_mul_f32 v51, v198, v51
    v_mul_f32 v52, v198, v52
    v_mul_f32 v53, v198, v53
    s_waitcnt lgkmcnt(4)
    v_mfma_f32_32x32x16_bf16 v[96:111], v[152:155], a[36:39], v[96:111]
    ds_read_b128 v[144:147], v200 offset:39936
    s_add_u32 s68, s64, 786432
    buffer_load_dwordx4 a[224:227], v13, s[16:19], s68 offen
    v_mul_f32 v54, v198, v54
    v_mul_f32 v55, v198, v55
    v_exp_f32 v160, v48
    s_waitcnt vmcnt(35)
    s_barrier
    v_mfma_f32_32x32x16_bf16 v[96:111], v[156:159], a[40:43], v[96:111]
    ds_read_b128 v[148:151], v200 offset:40960
    v_mul_f32 v56, v48, v56
    v_exp_f32 v161, v49
    v_mul_f32 v57, v49, v57
    s_waitcnt lgkmcnt(4)
    v_mfma_f32_32x32x16_bf16 v[96:111], v[128:131], a[44:47], v[96:111]
    ds_read_b128 v[152:155], v200 offset:41984
    buffer_load_dwordx4 a[228:231], v14, s[16:19], s68 offen
    v_exp_f32 v162, v50
    v_mul_f32 v58, v50, v58
    v_mfma_f32_32x32x16_bf16 v[96:111], v[132:135], a[48:51], v[96:111]
    ds_read_b128 v[156:159], v200 offset:43008
    v_exp_f32 v163, v51
    v_mul_f32 v59, v51, v59
    s_waitcnt lgkmcnt(4)
    v_mfma_f32_32x32x16_bf16 v[96:111], v[136:139], a[52:55], v[96:111]
    ds_read_b128 v[128:131], v200 offset:44032
    s_add_u32 s68, s65, 786432
    buffer_load_dwordx4 a[232:235], v13, s[16:19], s68 offen
    v_exp_f32 v164, v52
    v_mul_f32 v60, v52, v60
    v_mfma_f32_32x32x16_bf16 v[96:111], v[140:143], a[56:59], v[96:111]
    ds_read_b128 v[132:135], v200 offset:45056
    v_exp_f32 v165, v53
    v_mul_f32 v61, v53, v61
    s_waitcnt lgkmcnt(4)
    v_mfma_f32_32x32x16_bf16 v[96:111], v[144:147], a[60:63], v[96:111]
    ds_read_b128 v[136:139], v200 offset:46080
    buffer_load_dwordx4 a[236:239], v14, s[16:19], s68 offen
    v_exp_f32 v166, v54
    v_mul_f32 v62, v54, v62
    v_mfma_f32_32x32x16_bf16 v[96:111], v[148:151], a[64:67], v[96:111]
    ds_read_b128 v[140:143], v200 offset:47104
    v_exp_f32 v167, v55
    v_mul_f32 v63, v55, v63
    v_fma_f32 v160, v160, v199, v199
    s_waitcnt lgkmcnt(4)
    v_mfma_f32_32x32x16_bf16 v[96:111], v[152:155], a[68:71], v[96:111]
    ds_read_b128 v[144:147], v200 offset:48128
    s_add_u32 s68, s66, 786432
    buffer_load_dwordx4 a[240:243], v13, s[16:19], s68 offen
    v_fma_f32 v161, v161, v199, v199
    v_fma_f32 v162, v162, v199, v199
    v_fma_f32 v163, v163, v199, v199
    v_fma_f32 v164, v164, v199, v199
    v_mfma_f32_32x32x16_bf16 v[96:111], v[156:159], a[72:75], v[96:111]
    ds_read_b128 v[148:151], v200 offset:49152
    v_fma_f32 v165, v165, v199, v199
    v_fma_f32 v166, v166, v199, v199
    v_fma_f32 v167, v167, v199, v199
    s_waitcnt lgkmcnt(4)
    v_mfma_f32_32x32x16_bf16 v[96:111], v[128:131], a[76:79], v[96:111]
    ds_read_b128 v[152:155], v200 offset:50176
    buffer_load_dwordx4 a[244:247], v14, s[16:19], s68 offen
    v_rcp_f32 v160, v160
    v_rcp_f32 v161, v161
    v_mfma_f32_32x32x16_bf16 v[96:111], v[132:135], a[80:83], v[96:111]
    ds_read_b128 v[156:159], v200 offset:51200
    v_mul_f32 v56, v56, v160
    v_rcp_f32 v162, v162
    v_mul_f32 v57, v57, v161
    s_waitcnt lgkmcnt(4)
    v_mfma_f32_32x32x16_bf16 v[96:111], v[136:139], a[84:87], v[96:111]
    ds_read_b128 v[128:131], v200 offset:52224
    s_add_u32 s68, s67, 786432
    buffer_load_dwordx4 a[248:251], v13, s[16:19], s68 offen
    v_rcp_f32 v163, v163
    v_mul_f32 v58, v58, v162
    v_mfma_f32_32x32x16_bf16 v[96:111], v[140:143], a[88:91], v[96:111]
    ds_read_b128 v[132:135], v200 offset:53248
    v_rcp_f32 v164, v164
    v_mul_f32 v59, v59, v163
    s_waitcnt lgkmcnt(4)
    v_mfma_f32_32x32x16_bf16 v[96:111], v[144:147], a[92:95], v[96:111]
    ds_read_b128 v[136:139], v200 offset:54272
    buffer_load_dwordx4 a[252:255], v14, s[16:19], s68 offen
    v_rcp_f32 v165, v165
    v_mul_f32 v60, v60, v164
    v_mfma_f32_32x32x16_bf16 v[96:111], v[148:151], a[96:99], v[96:111]
    ds_read_b128 v[140:143], v200 offset:55296
    v_rcp_f32 v166, v166
    v_mul_f32 v61, v61, v165
    s_waitcnt lgkmcnt(4)
    v_mfma_f32_32x32x16_bf16 v[96:111], v[152:155], a[100:103], v[96:111]
    ds_read_b128 v[144:147], v200 offset:56320
    s_add_u32 s68, s64, 1048576
    buffer_load_dwordx4 v[208:211], v13, s[16:19], s68 offen
    v_rcp_f32 v167, v167
    v_mul_f32 v62, v62, v166
    v_mul_f32 v63, v63, v167
    v_mfma_f32_32x32x16_bf16 v[96:111], v[156:159], a[104:107], v[96:111]
    ds_read_b128 v[148:151], v200 offset:5120
    v_cvt_pk_bf16_f32 v168, v56, v57
    v_cvt_pk_bf16_f32 v169, v58, v59
    v_cvt_pk_bf16_f32 v170, v60, v61
    s_add_u32 s54, s53, 2097152
    s_waitcnt vmcnt(39)
    s_barrier
    s_waitcnt lgkmcnt(4)
    v_mfma_f32_32x32x16_bf16 v[96:111], v[128:131], a[108:111], v[96:111]
    ds_read_b128 v[152:155], v200 offset:57344
    buffer_load_dwordx4 v[212:215], v14, s[16:19], s68 offen
    v_cvt_pk_bf16_f32 v171, v62, v63
    buffer_store_dwordx4 v[168:171], v2, s[16:19], s54 offen sc1
    v_mul_f32 v64, v198, v64
    v_mul_f32 v65, v198, v65
    v_mfma_f32_32x32x16_bf16 v[96:111], v[132:135], a[112:115], v[96:111]
    ds_read_b128 v[156:159], v200 offset:58368
    v_mul_f32 v66, v198, v66
    v_mul_f32 v67, v198, v67
    v_mul_f32 v68, v198, v68
    v_mul_f32 v69, v198, v69
    s_waitcnt lgkmcnt(4)
    v_mfma_f32_32x32x16_bf16 v[96:111], v[136:139], a[116:119], v[96:111]
    ds_read_b128 v[128:131], v200 offset:59392
    s_add_u32 s68, s65, 1048576
    buffer_load_dwordx4 v[216:219], v13, s[16:19], s68 offen
    v_mul_f32 v70, v198, v70
    v_mul_f32 v71, v198, v71
    v_exp_f32 v160, v64
    v_mfma_f32_32x32x16_bf16 v[96:111], v[140:143], a[120:123], v[96:111]
    ds_read_b128 v[132:135], v200 offset:60416
    v_mul_f32 v72, v64, v72
    v_exp_f32 v161, v65
    v_mul_f32 v73, v65, v73
    s_waitcnt lgkmcnt(4)
    v_mfma_f32_32x32x16_bf16 v[96:111], v[144:147], a[124:127], v[96:111]
    ds_read_b128 v[136:139], v200 offset:61440
    buffer_load_dwordx4 v[220:223], v14, s[16:19], s68 offen
    v_exp_f32 v162, v66
    v_mul_f32 v74, v66, v74
    v_mfma_f32_32x32x16_bf16 v[96:111], v[148:151], v[192:195], v[96:111]
    ds_read_b128 v[140:143], v200 offset:62464
    v_exp_f32 v163, v67
    v_mul_f32 v75, v67, v75
    s_waitcnt lgkmcnt(4)
    v_mfma_f32_32x32x16_bf16 v[112:127], v[152:155], a[0:3], 0
    ds_read_b128 v[144:147], v200 offset:63488
    s_add_u32 s68, s66, 1048576
    buffer_load_dwordx4 v[224:227], v13, s[16:19], s68 offen
    v_exp_f32 v164, v68
    v_mul_f32 v76, v68, v76
    v_mfma_f32_32x32x16_bf16 v[112:127], v[156:159], a[4:7], v[112:127]
    ds_read_b128 v[148:151], v200 offset:64512
    v_exp_f32 v165, v69
    v_mul_f32 v77, v69, v77
    s_waitcnt lgkmcnt(4)
    v_mfma_f32_32x32x16_bf16 v[112:127], v[128:131], a[8:11], v[112:127]
    ds_read_b128 v[152:155], v201 offset:0
    buffer_load_dwordx4 v[228:231], v14, s[16:19], s68 offen
    v_exp_f32 v166, v70
    v_mul_f32 v78, v70, v78
    v_mfma_f32_32x32x16_bf16 v[112:127], v[132:135], a[12:15], v[112:127]
    ds_read_b128 v[156:159], v201 offset:1024
    v_exp_f32 v167, v71
    v_mul_f32 v79, v71, v79
    v_fma_f32 v160, v160, v199, v199
    s_waitcnt lgkmcnt(4)
    v_mfma_f32_32x32x16_bf16 v[112:127], v[136:139], a[16:19], v[112:127]
    ds_read_b128 v[128:131], v201 offset:2048
    s_add_u32 s68, s67, 1048576
    buffer_load_dwordx4 v[232:235], v13, s[16:19], s68 offen
    v_fma_f32 v161, v161, v199, v199
    v_fma_f32 v162, v162, v199, v199
    v_fma_f32 v163, v163, v199, v199
    v_fma_f32 v164, v164, v199, v199
    v_mfma_f32_32x32x16_bf16 v[112:127], v[140:143], a[20:23], v[112:127]
    ds_read_b128 v[132:135], v201 offset:3072
    v_fma_f32 v165, v165, v199, v199
    v_fma_f32 v166, v166, v199, v199
    v_fma_f32 v167, v167, v199, v199
    s_waitcnt lgkmcnt(4)
    v_mfma_f32_32x32x16_bf16 v[112:127], v[144:147], a[24:27], v[112:127]
    ds_read_b128 v[136:139], v201 offset:4096
    buffer_load_dwordx4 v[236:239], v14, s[16:19], s68 offen
    v_rcp_f32 v160, v160
    v_rcp_f32 v161, v161
    v_mfma_f32_32x32x16_bf16 v[112:127], v[148:151], a[28:31], v[112:127]
    ds_read_b128 v[140:143], v201 offset:5120
    v_mul_f32 v72, v72, v160
    v_rcp_f32 v162, v162
    v_mul_f32 v73, v73, v161
    s_waitcnt lgkmcnt(4)
    v_mfma_f32_32x32x16_bf16 v[112:127], v[152:155], a[32:35], v[112:127]
    ds_read_b128 v[144:147], v201 offset:6144
    s_add_u32 s68, s64, 1310720
    buffer_load_dwordx4 v[240:243], v13, s[16:19], s68 offen
    v_rcp_f32 v163, v163
    v_mul_f32 v74, v74, v162
    v_mfma_f32_32x32x16_bf16 v[112:127], v[156:159], a[36:39], v[112:127]
    ds_read_b128 v[148:151], v201 offset:7168
    v_rcp_f32 v164, v164
    v_mul_f32 v75, v75, v163
    s_waitcnt vmcnt(44)
    s_barrier
    s_waitcnt lgkmcnt(4)
    v_mfma_f32_32x32x16_bf16 v[112:127], v[128:131], a[40:43], v[112:127]
    ds_read_b128 v[152:155], v201 offset:8192
    buffer_load_dwordx4 v[244:247], v14, s[16:19], s68 offen
    v_rcp_f32 v165, v165
    v_mul_f32 v76, v76, v164
    v_mfma_f32_32x32x16_bf16 v[112:127], v[132:135], a[44:47], v[112:127]
    ds_read_b128 v[156:159], v201 offset:9216
    v_rcp_f32 v166, v166
    v_mul_f32 v77, v77, v165
    s_waitcnt lgkmcnt(4)
    v_mfma_f32_32x32x16_bf16 v[112:127], v[136:139], a[48:51], v[112:127]
    ds_read_b128 v[128:131], v201 offset:10240
    s_add_u32 s68, s65, 1310720
    buffer_load_dwordx4 v[248:251], v13, s[16:19], s68 offen
    v_rcp_f32 v167, v167
    v_mul_f32 v78, v78, v166
    v_mul_f32 v79, v79, v167
    v_mfma_f32_32x32x16_bf16 v[112:127], v[140:143], a[52:55], v[112:127]
    ds_read_b128 v[132:135], v201 offset:11264
    v_cvt_pk_bf16_f32 v172, v72, v73
    v_cvt_pk_bf16_f32 v173, v74, v75
    v_cvt_pk_bf16_f32 v174, v76, v77
    s_add_u32 s54, s53, 3145728
    s_waitcnt lgkmcnt(4)
    v_mfma_f32_32x32x16_bf16 v[112:127], v[144:147], a[56:59], v[112:127]
    ds_read_b128 v[136:139], v201 offset:12288
    buffer_load_dwordx4 v[252:255], v14, s[16:19], s68 offen
    v_cvt_pk_bf16_f32 v175, v78, v79
    buffer_store_dwordx4 v[172:175], v2, s[16:19], s54 offen sc1
    v_mul_f32 v80, v198, v80
    v_mul_f32 v81, v198, v81
    v_mfma_f32_32x32x16_bf16 v[112:127], v[148:151], a[60:63], v[112:127]
    ds_read_b128 v[140:143], v201 offset:13312
    v_mul_f32 v82, v198, v82
    v_mul_f32 v83, v198, v83
    v_mul_f32 v84, v198, v84
    v_mul_f32 v85, v198, v85
    s_waitcnt lgkmcnt(4)
    v_mfma_f32_32x32x16_bf16 v[112:127], v[152:155], a[64:67], v[112:127]
    ds_read_b128 v[144:147], v201 offset:14336
    s_add_u32 s69, s64, 0
    buffer_load_dwordx4 a[0:3], v15, s[16:19], s69 offen sc1
    v_mul_f32 v86, v198, v86
    v_mul_f32 v87, v198, v87
    v_exp_f32 v160, v80
    v_mfma_f32_32x32x16_bf16 v[112:127], v[156:159], a[68:71], v[112:127]
    ds_read_b128 v[148:151], v201 offset:15360
    buffer_load_dwordx4 a[4:7], v7, s[16:19], s69 offen sc1
    v_mul_f32 v88, v80, v88
    v_exp_f32 v161, v81
    s_waitcnt lgkmcnt(4)
    v_mfma_f32_32x32x16_bf16 v[112:127], v[128:131], a[72:75], v[112:127]
    ds_read_b128 v[152:155], v201 offset:16384
    s_add_u32 s69, s65, 0
    buffer_load_dwordx4 a[8:11], v15, s[16:19], s69 offen sc1
    v_mul_f32 v89, v81, v89
    v_exp_f32 v162, v82
    v_mul_f32 v90, v82, v90
    v_mfma_f32_32x32x16_bf16 v[112:127], v[132:135], a[76:79], v[112:127]
    ds_read_b128 v[156:159], v201 offset:17408
    buffer_load_dwordx4 a[12:15], v7, s[16:19], s69 offen sc1
    v_exp_f32 v163, v83
    v_mul_f32 v91, v83, v91
    s_waitcnt lgkmcnt(4)
    v_mfma_f32_32x32x16_bf16 v[112:127], v[136:139], a[80:83], v[112:127]
    ds_read_b128 v[128:131], v201 offset:18432
    s_add_u32 s69, s66, 0
    buffer_load_dwordx4 a[16:19], v15, s[16:19], s69 offen sc1
    v_exp_f32 v164, v84
    v_mul_f32 v92, v84, v92
    v_mfma_f32_32x32x16_bf16 v[112:127], v[140:143], a[84:87], v[112:127]
    ds_read_b128 v[132:135], v201 offset:19456
    buffer_load_dwordx4 a[20:23], v7, s[16:19], s69 offen sc1
    v_exp_f32 v165, v85
    v_mul_f32 v93, v85, v93
    s_waitcnt lgkmcnt(4)
    v_mfma_f32_32x32x16_bf16 v[112:127], v[144:147], a[88:91], v[112:127]
    ds_read_b128 v[136:139], v201 offset:20480
    s_add_u32 s69, s67, 0
    buffer_load_dwordx4 a[24:27], v15, s[16:19], s69 offen sc1
    v_exp_f32 v166, v86
    v_mul_f32 v94, v86, v94
    v_mfma_f32_32x32x16_bf16 v[112:127], v[148:151], a[92:95], v[112:127]
    ds_read_b128 v[140:143], v201 offset:21504
    buffer_load_dwordx4 a[28:31], v7, s[16:19], s69 offen sc1
    v_exp_f32 v167, v87
    v_mul_f32 v95, v87, v95
    s_waitcnt lgkmcnt(4)
    v_mfma_f32_32x32x16_bf16 v[112:127], v[152:155], a[96:99], v[112:127]
    ds_read_b128 v[144:147], v201 offset:22528
    v_fma_f32 v160, v160, v199, v199
    v_fma_f32 v161, v161, v199, v199
    v_fma_f32 v162, v162, v199, v199
    v_fma_f32 v163, v163, v199, v199
    v_fma_f32 v164, v164, v199, v199
    v_mfma_f32_32x32x16_bf16 v[112:127], v[156:159], a[100:103], v[112:127]
    ds_read_b128 v[148:151], v201 offset:23552
    v_fma_f32 v165, v165, v199, v199
    v_fma_f32 v166, v166, v199, v199
    v_fma_f32 v167, v167, v199, v199
    s_waitcnt lgkmcnt(4)
    v_mfma_f32_32x32x16_bf16 v[112:127], v[128:131], a[104:107], v[112:127]
    ds_read_b128 v[152:155], v200 offset:6144
    v_rcp_f32 v160, v160
    v_rcp_f32 v161, v161
    v_mul_f32 v88, v88, v160
    v_mfma_f32_32x32x16_bf16 v[112:127], v[132:135], a[108:111], v[112:127]
    v_rcp_f32 v162, v162
    v_mul_f32 v89, v89, v161
    s_waitcnt lgkmcnt(3)
    v_mfma_f32_32x32x16_bf16 v[112:127], v[136:139], a[112:115], v[112:127]
    v_rcp_f32 v163, v163
    v_mul_f32 v90, v90, v162
    v_rcp_f32 v164, v164
    v_mfma_f32_32x32x16_bf16 v[112:127], v[140:143], a[116:119], v[112:127]
    v_mul_f32 v91, v91, v163
    v_rcp_f32 v165, v165
    v_mul_f32 v92, v92, v164
    s_waitcnt lgkmcnt(1)
    v_mfma_f32_32x32x16_bf16 v[112:127], v[144:147], a[120:123], v[112:127]
    v_rcp_f32 v166, v166
    v_mul_f32 v93, v93, v165
    v_rcp_f32 v167, v167
    v_mfma_f32_32x32x16_bf16 v[112:127], v[148:151], a[124:127], v[112:127]
    v_mul_f32 v94, v94, v166
    v_mul_f32 v95, v95, v167
    v_cvt_pk_bf16_f32 v168, v88, v89
    v_cvt_pk_bf16_f32 v169, v90, v91
    s_waitcnt lgkmcnt(0)
    v_mfma_f32_32x32x16_bf16 v[112:127], v[152:155], v[192:195], v[112:127]
    v_cvt_pk_bf16_f32 v170, v92, v93
    s_add_u32 s54, s53, 4194304
    v_cvt_pk_bf16_f32 v171, v94, v95
    buffer_store_dwordx4 v[168:171], v2, s[16:19], s54 offen sc1
    v_mul_f32 v96, v198, v96
    s_waitcnt vmcnt(7)
    v_accvgpr_read_b32 v4, a0
    v_accvgpr_read_b32 v5, a1
    v_accvgpr_read_b32 v6, a2
    v_accvgpr_read_b32 v0, a3
    v_max3_u32 v203, v4, v5, v6
    v_max_u32 v203, v203, v0
    v_accvgpr_read_b32 v4, a4
    v_accvgpr_read_b32 v5, a5
    v_accvgpr_read_b32 v6, a6
    v_accvgpr_read_b32 v0, a7
    v_max3_u32 v203, v203, v4, v5
    v_max3_u32 v203, v203, v6, v0
    v_cmp_eq_u32 vcc, -1, v203
    s_nop 3
    s_cbranch_vccnz L_rt_b0
L_ok_b0:
    s_waitcnt vmcnt(5)
    v_mfma_f32_32x32x16_bf16 v[32:47], a[132:135], a[0:3], 0
    s_add_u32 s69, s64, 1048576
    buffer_load_dwordx4 a[32:35], v15, s[16:19], s69 offen sc1
    buffer_load_dwordx4 a[36:39], v7, s[16:19], s69 offen sc1
    v_mul_f32 v97, v198, v97
    v_mul_f32 v98, v198, v98
    v_mul_f32 v99, v198, v99
    v_mul_f32 v100, v198, v100
    v_mul_f32 v101, v198, v101
    v_mul_f32 v102, v198, v102
    v_mul_f32 v103, v198, v103
    v_exp_f32 v160, v96
    v_mul_f32 v104, v96, v104
    v_accvgpr_read_b32 v4, a8
    v_accvgpr_read_b32 v5, a9
    v_accvgpr_read_b32 v6, a10
    v_accvgpr_read_b32 v0, a11
    v_max3_u32 v203, v4, v5, v6
    v_mfma_f32_32x32x16_bf16 v[48:63], a[128:131], a[4:7], 0
    s_add_u32 s68, s66, 1310720
    buffer_load_dwordx4 v[128:131], v13, s[16:19], s68 offen
    v_exp_f32 v161, v97
    v_mul_f32 v105, v97, v105
    v_exp_f32 v162, v98
    v_mul_f32 v106, v98, v106
    v_exp_f32 v163, v99
    v_mul_f32 v107, v99, v107
    v_max_u32 v203, v203, v0
    v_accvgpr_read_b32 v4, a12
    v_accvgpr_read_b32 v5, a13
    v_accvgpr_read_b32 v6, a14
    v_accvgpr_read_b32 v0, a15
    v_mfma_f32_32x32x16_bf16 v[64:79], a[132:135], a[4:7], 0
    s_add_u32 s69, s65, 1048576
    buffer_load_dwordx4 a[40:43], v15, s[16:19], s69 offen sc1
    buffer_load_dwordx4 a[44:47], v7, s[16:19], s69 offen sc1
    v_exp_f32 v164, v100
    v_mul_f32 v108, v100, v108
    v_exp_f32 v165, v101
    v_mul_f32 v109, v101, v109
    v_exp_f32 v166, v102
    v_mul_f32 v110, v102, v110
    v_max3_u32 v203, v203, v4, v5
    v_max3_u32 v203, v203, v6, v0
    v_cmp_eq_u32 vcc, -1, v203
    v_mfma_f32_32x32x16_bf16 v[16:31], a[128:131], a[0:3], 0
    v_exp_f32 v167, v103
    v_mul_f32 v111, v103, v111
    v_fma_f32 v160, v160, v199, v199
    v_fma_f32 v161, v161, v199, v199
    v_fma_f32 v162, v162, v199, v199
    v_fma_f32 v163, v163, v199, v199
    v_fma_f32 v164, v164, v199, v199
    v_fma_f32 v165, v165, v199, v199
    v_fma_f32 v166, v166, v199, v199
    s_cbranch_vccnz L_rt_b1
L_ok_b1:
    s_waitcnt vmcnt(8)
    v_mfma_f32_32x32x16_bf16 v[32:47], a[140:143], a[8:11], v[32:47]
    s_add_u32 s69, s66, 1048576
    buffer_load_dwordx4 a[48:51], v15, s[16:19], s69 offen sc1
    buffer_load_dwordx4 a[52:55], v7, s[16:19], s69 offen sc1
    v_fma_f32 v167, v167, v199, v199
    v_rcp_f32 v160, v160
    v_rcp_f32 v161, v161
    v_mul_f32 v104, v104, v160
    v_rcp_f32 v162, v162
    v_mul_f32 v105, v105, v161
    v_accvgpr_read_b32 v4, a16
    v_accvgpr_read_b32 v5, a17
    v_accvgpr_read_b32 v6, a18
    v_accvgpr_read_b32 v0, a19
    v_max3_u32 v203, v4, v5, v6
    v_mfma_f32_32x32x16_bf16 v[48:63], a[136:139], a[12:15], v[48:63]
    buffer_load_dwordx4 v[132:135], v14, s[16:19], s68 offen
    v_rcp_f32 v163, v163
    v_mul_f32 v106, v106, v162
    v_rcp_f32 v164, v164
    v_mul_f32 v107, v107, v163
    v_rcp_f32 v165, v165
    v_mul_f32 v108, v108, v164
    v_max_u32 v203, v203, v0
    v_accvgpr_read_b32 v4, a20
    v_accvgpr_read_b32 v5, a21
    v_accvgpr_read_b32 v6, a22
    v_accvgpr_read_b32 v0, a23
    v_mfma_f32_32x32x16_bf16 v[64:79], a[140:143], a[12:15], v[64:79]
    v_rcp_f32 v166, v166
    v_mul_f32 v109, v109, v165
    v_rcp_f32 v167, v167
    v_mul_f32 v110, v110, v166
    v_mul_f32 v111, v111, v167
    v_cvt_pk_bf16_f32 v172, v104, v105
    v_cvt_pk_bf16_f32 v173, v106, v107
    v_cvt_pk_bf16_f32 v174, v108, v109
    v_max3_u32 v203, v203, v4, v5
    v_max3_u32 v203, v203, v6, v0
    v_cmp_eq_u32 vcc, -1, v203
    v_mfma_f32_32x32x16_bf16 v[16:31], a[136:139], a[8:11], v[16:31]
    s_add_u32 s54, s53, 5242880
    v_cvt_pk_bf16_f32 v175, v110, v111
    buffer_store_dwordx4 v[172:175], v2, s[16:19], s54 offen sc1
    v_mul_f32 v112, v198, v112
    v_mul_f32 v113, v198, v113
    v_mul_f32 v114, v198, v114
    v_mul_f32 v115, v198, v115
    v_mul_f32 v116, v198, v116
    v_mul_f32 v117, v198, v117
    v_mul_f32 v118, v198, v118
    s_cbranch_vccnz L_rt_b2
L_ok_b2:
    s_waitcnt vmcnt(10)
    v_mfma_f32_32x32x16_bf16 v[32:47], a[148:151], a[16:19], v[32:47]
    s_add_u32 s69, s67, 1048576
    buffer_load_dwordx4 a[56:59], v15, s[16:19], s69 offen sc1
    buffer_load_dwordx4 a[60:63], v7, s[16:19], s69 offen sc1
    v_mul_f32 v119, v198, v119
    v_exp_f32 v160, v112
    v_mul_f32 v120, v112, v120
    v_exp_f32 v161, v113
    v_mul_f32 v121, v113, v121
    v_exp_f32 v162, v114
    v_mul_f32 v122, v114, v122
    v_accvgpr_read_b32 v4, a24
    v_accvgpr_read_b32 v5, a25
    v_accvgpr_read_b32 v6, a26
    v_accvgpr_read_b32 v0, a27
    v_max3_u32 v203, v4, v5, v6
    v_mfma_f32_32x32x16_bf16 v[48:63], a[144:147], a[20:23], v[48:63]
    s_add_u32 s68, s67, 1310720
    buffer_load_dwordx4 v[136:139], v13, s[16:19], s68 offen
    v_exp_f32 v163, v115
    v_mul_f32 v123, v115, v123
    v_exp_f32 v164, v116
    v_mul_f32 v124, v116, v124
    v_exp_f32 v165, v117
    v_mul_f32 v125, v117, v125
    v_max_u32 v203, v203, v0
    v_accvgpr_read_b32 v4, a28
    v_accvgpr_read_b32 v5, a29
    v_accvgpr_read_b32 v6, a30
    v_accvgpr_read_b32 v0, a31
    v_mfma_f32_32x32x16_bf16 v[64:79], a[148:151], a[20:23], v[64:79]
    v_exp_f32 v166, v118
    v_mul_f32 v126, v118, v126
    v_exp_f32 v167, v119
    v_mul_f32 v127, v119, v127
    v_fma_f32 v160, v160, v199, v199
    v_fma_f32 v161, v161, v199, v199
    v_fma_f32 v162, v162, v199, v199
    v_fma_f32 v163, v163, v199, v199
    v_max3_u32 v203, v203, v4, v5
    v_max3_u32 v203, v203, v6, v0
    v_cmp_eq_u32 vcc, -1, v203
    v_mfma_f32_32x32x16_bf16 v[16:31], a[144:147], a[16:19], v[16:31]
    v_fma_f32 v164, v164, v199, v199
    v_fma_f32 v165, v165, v199, v199
    v_fma_f32 v166, v166, v199, v199
    v_fma_f32 v167, v167, v199, v199
    v_rcp_f32 v160, v160
    v_rcp_f32 v161, v161
    v_mul_f32 v120, v120, v160
    s_cbranch_vccnz L_rt_b3
L_ok_b3:
    s_waitcnt vmcnt(10)
    v_mfma_f32_32x32x16_bf16 v[32:47], a[156:159], a[24:27], v[32:47]
    s_add_u32 s69, s64, 2097152
    buffer_load_dwordx4 a[64:67], v15, s[16:19], s69 offen sc1
    buffer_load_dwordx4 a[68:71], v7, s[16:19], s69 offen sc1
    v_rcp_f32 v162, v162
    v_mul_f32 v121, v121, v161
    v_rcp_f32 v163, v163
    v_mul_f32 v122, v122, v162
    v_rcp_f32 v164, v164
    v_mul_f32 v123, v123, v163
    v_accvgpr_read_b32 v4, a32
    v_accvgpr_read_b32 v5, a33
    v_accvgpr_read_b32 v6, a34
    v_accvgpr_read_b32 v0, a35
    v_max3_u32 v203, v4, v5, v6
    v_mfma_f32_32x32x16_bf16 v[48:63], a[152:155], a[28:31], v[48:63]
    buffer_load_dwordx4 v[140:143], v14, s[16:19], s68 offen
    v_rcp_f32 v165, v165
    v_mul_f32 v124, v124, v164
    v_rcp_f32 v166, v166
    v_mul_f32 v125, v125, v165
    v_rcp_f32 v167, v167
    v_mul_f32 v126, v126, v166
    v_mul_f32 v127, v127, v167
    v_max_u32 v203, v203, v0
    v_accvgpr_read_b32 v4, a36
    v_accvgpr_read_b32 v5, a37
    v_accvgpr_read_b32 v6, a38
    v_accvgpr_read_b32 v0, a39
    v_mfma_f32_32x32x16_bf16 v[64:79], a[156:159], a[28:31], v[64:79]
    v_cvt_pk_bf16_f32 v168, v120, v121
    v_cvt_pk_bf16_f32 v169, v122, v123
    v_cvt_pk_bf16_f32 v170, v124, v125
    s_add_u32 s54, s53, 6291456
    v_cvt_pk_bf16_f32 v171, v126, v127
    buffer_store_dwordx4 v[168:171], v2, s[16:19], s54 offen sc1
    v_max3_u32 v203, v203, v4, v5
    v_max3_u32 v203, v203, v6, v0
    v_cmp_eq_u32 vcc, -1, v203
    v_mfma_f32_32x32x16_bf16 v[16:31], a[152:155], a[24:27], v[16:31]
    s_cbranch_vccnz L_rt_b4
L_ok_b4:
    s_waitcnt vmcnt(11)
    v_mfma_f32_32x32x16_bf16 v[32:47], a[164:167], a[32:35], v[32:47]
    s_add_u32 s69, s65, 2097152
    buffer_load_dwordx4 a[72:75], v15, s[16:19], s69 offen sc1
    buffer_load_dwordx4 a[76:79], v7, s[16:19], s69 offen sc1
    v_accvgpr_read_b32 v4, a40
    v_accvgpr_read_b32 v5, a41
    v_accvgpr_read_b32 v6, a42
    v_accvgpr_read_b32 v0, a43
    v_max3_u32 v203, v4, v5, v6
    v_mfma_f32_32x32x16_bf16 v[48:63], a[160:163], a[36:39], v[48:63]
    s_add_u32 s68, s64, 1572864
    buffer_load_dwordx4 v[144:147], v13, s[16:19], s68 offen
    v_max_u32 v203, v203, v0
    v_accvgpr_read_b32 v4, a44
    v_accvgpr_read_b32 v5, a45
    v_accvgpr_read_b32 v6, a46
    v_accvgpr_read_b32 v0, a47
    v_mfma_f32_32x32x16_bf16 v[64:79], a[164:167], a[36:39], v[64:79]
    v_max3_u32 v203, v203, v4, v5
    v_max3_u32 v203, v203, v6, v0
    v_cmp_eq_u32 vcc, -1, v203
    v_mfma_f32_32x32x16_bf16 v[16:31], a[160:163], a[32:35], v[16:31]
    s_cbranch_vccnz L_rt_b5
L_ok_b5:
    s_waitcnt vmcnt(12)
    v_mfma_f32_32x32x16_bf16 v[32:47], a[172:175], a[40:43], v[32:47]
    s_add_u32 s69, s66, 2097152
    buffer_load_dwordx4 a[80:83], v15, s[16:19], s69 offen sc1
    buffer_load_dwordx4 a[84:87], v7, s[16:19], s69 offen sc1
    v_accvgpr_read_b32 v4, a48
    v_accvgpr_read_b32 v5, a49
    v_accvgpr_read_b32 v6, a50
    v_accvgpr_read_b32 v0, a51
    v_max3_u32 v203, v4, v5, v6
    v_mfma_f32_32x32x16_bf16 v[48:63], a[168:171], a[44:47], v[48:63]
    buffer_load_dwordx4 v[148:151], v14, s[16:19], s68 offen
    v_max_u32 v203, v203, v0
    v_accvgpr_read_b32 v4, a52
    v_accvgpr_read_b32 v5, a53
    v_accvgpr_read_b32 v6, a54
    v_accvgpr_read_b32 v0, a55
    v_mfma_f32_32x32x16_bf16 v[64:79], a[172:175], a[44:47], v[64:79]
    v_max3_u32 v203, v203, v4, v5
    v_max3_u32 v203, v203, v6, v0
    v_cmp_eq_u32 vcc, -1, v203
    v_mfma_f32_32x32x16_bf16 v[16:31], a[168:171], a[40:43], v[16:31]
    s_cbranch_vccnz L_rt_b6
L_ok_b6:
    s_waitcnt vmcnt(11)
    v_mfma_f32_32x32x16_bf16 v[32:47], a[180:183], a[48:51], v[32:47]
    s_add_u32 s69, s67, 2097152
    buffer_load_dwordx4 a[88:91], v15, s[16:19], s69 offen sc1
    buffer_load_dwordx4 a[92:95], v7, s[16:19], s69 offen sc1
    v_accvgpr_read_b32 v4, a56
    v_accvgpr_read_b32 v5, a57
    v_accvgpr_read_b32 v6, a58
    v_accvgpr_read_b32 v0, a59
    v_max3_u32 v203, v4, v5, v6
    v_mfma_f32_32x32x16_bf16 v[48:63], a[176:179], a[52:55], v[48:63]
    s_add_u32 s68, s65, 1572864
    buffer_load_dwordx4 v[152:155], v13, s[16:19], s68 offen
    v_max_u32 v203, v203, v0
    v_accvgpr_read_b32 v4, a60
    v_accvgpr_read_b32 v5, a61
    v_accvgpr_read_b32 v6, a62
    v_accvgpr_read_b32 v0, a63
    v_mfma_f32_32x32x16_bf16 v[64:79], a[180:183], a[52:55], v[64:79]
    v_max3_u32 v203, v203, v4, v5
    v_max3_u32 v203, v203, v6, v0
    v_cmp_eq_u32 vcc, -1, v203
    v_mfma_f32_32x32x16_bf16 v[16:31], a[176:179], a[48:51], v[16:31]
    s_cbranch_vccnz L_rt_b7
L_ok_b7:
    s_waitcnt vmcnt(11)
    v_mfma_f32_32x32x16_bf16 v[32:47], a[188:191], a[56:59], v[32:47]
    s_add_u32 s69, s64, 3145728
    buffer_load_dwordx4 a[96:99], v15, s[16:19], s69 offen sc1
    buffer_load_dwordx4 a[100:103], v7, s[16:19], s69 offen sc1
    v_accvgpr_read_b32 v4, a64
    v_accvgpr_read_b32 v5, a65
    v_accvgpr_read_b32 v6, a66
    v_accvgpr_read_b32 v0, a67
    v_max3_u32 v203, v4, v5, v6
    v_mfma_f32_32x32x16_bf16 v[48:63], a[184:187], a[60:63], v[48:63]
    buffer_load_dwordx4 v[156:159], v14, s[16:19], s68 offen
    v_max_u32 v203, v203, v0
    v_accvgpr_read_b32 v4, a68
    v_accvgpr_read_b32 v5, a69
    v_accvgpr_read_b32 v6, a70
    v_accvgpr_read_b32 v0, a71
    v_mfma_f32_32x32x16_bf16 v[64:79], a[188:191], a[60:63], v[64:79]
    v_max3_u32 v203, v203, v4, v5
    v_max3_u32 v203, v203, v6, v0
    v_cmp_eq_u32 vcc, -1, v203
    v_mfma_f32_32x32x16_bf16 v[16:31], a[184:187], a[56:59], v[16:31]
    s_cbranch_vccnz L_rt_b8
L_ok_b8:
    s_waitcnt vmcnt(10)
    s_barrier
    v_mfma_f32_32x32x16_bf16 v[32:47], a[196:199], a[64:67], v[32:47]
    s_add_u32 s69, s65, 3145728
    buffer_load_dwordx4 a[104:107], v15, s[16:19], s69 offen sc1
    buffer_load_dwordx4 a[108:111], v7, s[16:19], s69 offen sc1
    v_accvgpr_read_b32 v4, a72
    v_accvgpr_read_b32 v5, a73
    v_accvgpr_read_b32 v6, a74
    v_accvgpr_read_b32 v0, a75
    v_max3_u32 v203, v4, v5, v6
    v_mfma_f32_32x32x16_bf16 v[48:63], a[192:195], a[68:71], v[48:63]
    s_add_u32 s68, s66, 1572864
    buffer_load_dwordx4 v[176:179], v13, s[16:19], s68 offen
    v_max_u32 v203, v203, v0
    v_accvgpr_read_b32 v4, a76
    v_accvgpr_read_b32 v5, a77
    v_accvgpr_read_b32 v6, a78
    v_accvgpr_read_b32 v0, a79
    v_mfma_f32_32x32x16_bf16 v[64:79], a[196:199], a[68:71], v[64:79]
    v_max3_u32 v203, v203, v4, v5
    v_max3_u32 v203, v203, v6, v0
    v_cmp_eq_u32 vcc, -1, v203
    v_mfma_f32_32x32x16_bf16 v[16:31], a[192:195], a[64:67], v[16:31]
    s_cbranch_vccnz L_rt_b9
L_ok_b9:
    s_waitcnt vmcnt(10)
    v_mfma_f32_32x32x16_bf16 v[32:47], a[204:207], a[72:75], v[32:47]
    s_add_u32 s69, s66, 3145728
    buffer_load_dwordx4 a[112:115], v15, s[16:19], s69 offen sc1
    buffer_load_dwordx4 a[116:119], v7, s[16:19], s69 offen sc1
    v_accvgpr_read_b32 v4, a80
    v_accvgpr_read_b32 v5, a81
    v_accvgpr_read_b32 v6, a82
    v_accvgpr_read_b32 v0, a83
    v_max3_u32 v203, v4, v5, v6
    v_mfma_f32_32x32x16_bf16 v[48:63], a[200:203], a[76:79], v[48:63]
    buffer_load_dwordx4 v[180:183], v14, s[16:19], s68 offen
    v_max_u32 v203, v203, v0
    v_accvgpr_read_b32 v4, a84
    v_accvgpr_read_b32 v5, a85
    v_accvgpr_read_b32 v6, a86
    v_accvgpr_read_b32 v0, a87
    v_mfma_f32_32x32x16_bf16 v[64:79], a[204:207], a[76:79], v[64:79]
    v_max3_u32 v203, v203, v4, v5
    v_max3_u32 v203, v203, v6, v0
    v_cmp_eq_u32 vcc, -1, v203
    v_mfma_f32_32x32x16_bf16 v[16:31], a[200:203], a[72:75], v[16:31]
    s_cbranch_vccnz L_rt_b10
L_ok_b10:
    s_waitcnt vmcnt(10)
    v_mfma_f32_32x32x16_bf16 v[32:47], a[212:215], a[80:83], v[32:47]
    s_add_u32 s69, s67, 3145728
    buffer_load_dwordx4 a[120:123], v15, s[16:19], s69 offen sc1
    buffer_load_dwordx4 a[124:127], v7, s[16:19], s69 offen sc1
    v_accvgpr_read_b32 v4, a88
    v_accvgpr_read_b32 v5, a89
    v_accvgpr_read_b32 v6, a90
    v_accvgpr_read_b32 v0, a91
    v_max3_u32 v203, v4, v5, v6
    v_mfma_f32_32x32x16_bf16 v[48:63], a[208:211], a[84:87], v[48:63]
    s_add_u32 s68, s67, 1572864
    buffer_load_dwordx4 v[184:187], v13, s[16:19], s68 offen
    v_max_u32 v203, v203, v0
    v_accvgpr_read_b32 v4, a92
    v_accvgpr_read_b32 v5, a93
    v_accvgpr_read_b32 v6, a94
    v_accvgpr_read_b32 v0, a95
    v_mfma_f32_32x32x16_bf16 v[64:79], a[212:215], a[84:87], v[64:79]
    v_max3_u32 v203, v203, v4, v5
    v_max3_u32 v203, v203, v6, v0
    v_cmp_eq_u32 vcc, -1, v203
    v_mfma_f32_32x32x16_bf16 v[16:31], a[208:211], a[80:83], v[16:31]
    s_cbranch_vccnz L_rt_b11
L_ok_b11:
    s_waitcnt vmcnt(10)
    v_mfma_f32_32x32x16_bf16 v[32:47], a[220:223], a[88:91], v[32:47]
    s_add_u32 s69, s64, 4194304
    buffer_load_dwordx4 v[80:83], v15, s[16:19], s69 offen sc1
    buffer_load_dwordx4 v[84:87], v7, s[16:19], s69 offen sc1
    v_accvgpr_read_b32 v4, a96
    v_accvgpr_read_b32 v5, a97
    v_accvgpr_read_b32 v6, a98
    v_accvgpr_read_b32 v0, a99
    v_max3_u32 v203, v4, v5, v6
    v_mfma_f32_32x32x16_bf16 v[48:63], a[216:219], a[92:95], v[48:63]
    buffer_load_dwordx4 v[188:191], v14, s[16:19], s68 offen
    v_max_u32 v203, v203, v0
    v_accvgpr_read_b32 v4, a100
    v_accvgpr_read_b32 v5, a101
    v_accvgpr_read_b32 v6, a102
    v_accvgpr_read_b32 v0, a103
    v_mfma_f32_32x32x16_bf16 v[64:79], a[220:223], a[92:95], v[64:79]
    v_max3_u32 v203, v203, v4, v5
    v_max3_u32 v203, v203, v6, v0
    v_cmp_eq_u32 vcc, -1, v203
    v_mfma_f32_32x32x16_bf16 v[16:31], a[216:219], a[88:91], v[16:31]
    s_cbranch_vccnz L_rt_b12
L_ok_b12:
    s_waitcnt vmcnt(10)
    v_mfma_f32_32x32x16_bf16 v[32:47], a[228:231], a[96:99], v[32:47]
    s_add_u32 s69, s65, 4194304
    buffer_load_dwordx4 v[88:91], v15, s[16:19], s69 offen sc1
    buffer_load_dwordx4 v[92:95], v7, s[16:19], s69 offen sc1
    v_accvgpr_read_b32 v4, a104
    v_accvgpr_read_b32 v5, a105
    v_accvgpr_read_b32 v6, a106
    v_accvgpr_read_b32 v0, a107
    v_max3_u32 v203, v4, v5, v6
    v_mfma_f32_32x32x16_bf16 v[48:63], a[224:227], a[100:103], v[48:63]
    v_max_u32 v203, v203, v0
    v_accvgpr_read_b32 v4, a108
    v_accvgpr_read_b32 v5, a109
    v_accvgpr_read_b32 v6, a110
    v_accvgpr_read_b32 v0, a111
    v_mfma_f32_32x32x16_bf16 v[64:79], a[228:231], a[100:103], v[64:79]
    v_max3_u32 v203, v203, v4, v5
    v_max3_u32 v203, v203, v6, v0
    v_cmp_eq_u32 vcc, -1, v203
    v_mfma_f32_32x32x16_bf16 v[16:31], a[224:227], a[96:99], v[16:31]
    s_cbranch_vccnz L_rt_b13
L_ok_b13:
    s_waitcnt vmcnt(9)
    v_mfma_f32_32x32x16_bf16 v[32:47], a[236:239], a[104:107], v[32:47]
    s_add_u32 s69, s66, 4194304
    buffer_load_dwordx4 v[96:99], v15, s[16:19], s69 offen sc1
    buffer_load_dwordx4 v[100:103], v7, s[16:19], s69 offen sc1
    v_accvgpr_read_b32 v4, a112
    v_accvgpr_read_b32 v5, a113
    v_accvgpr_read_b32 v6, a114
    v_accvgpr_read_b32 v0, a115
    v_max3_u32 v203, v4, v5, v6
    v_mfma_f32_32x32x16_bf16 v[48:63], a[232:235], a[108:111], v[48:63]
    v_max_u32 v203, v203, v0
    v_accvgpr_read_b32 v4, a116
    v_accvgpr_read_b32 v5, a117
    v_accvgpr_read_b32 v6, a118
    v_accvgpr_read_b32 v0, a119
    v_mfma_f32_32x32x16_bf16 v[64:79], a[236:239], a[108:111], v[64:79]
    v_max3_u32 v203, v203, v4, v5
    v_max3_u32 v203, v203, v6, v0
    v_cmp_eq_u32 vcc, -1, v203
    v_mfma_f32_32x32x16_bf16 v[16:31], a[232:235], a[104:107], v[16:31]
    s_cbranch_vccnz L_rt_b14
L_ok_b14:
    s_waitcnt vmcnt(8)
    v_mfma_f32_32x32x16_bf16 v[32:47], a[244:247], a[112:115], v[32:47]
    s_add_u32 s69, s67, 4194304
    buffer_load_dwordx4 v[104:107], v15, s[16:19], s69 offen sc1
    buffer_load_dwordx4 v[108:111], v7, s[16:19], s69 offen sc1
    v_accvgpr_read_b32 v4, a120
    v_accvgpr_read_b32 v5, a121
    v_accvgpr_read_b32 v6, a122
    v_accvgpr_read_b32 v0, a123
    v_max3_u32 v203, v4, v5, v6
    v_mfma_f32_32x32x16_bf16 v[48:63], a[240:243], a[116:119], v[48:63]
    v_max_u32 v203, v203, v0
    v_accvgpr_read_b32 v4, a124
    v_accvgpr_read_b32 v5, a125
    v_accvgpr_read_b32 v6, a126
    v_accvgpr_read_b32 v0, a127
    v_mfma_f32_32x32x16_bf16 v[64:79], a[244:247], a[116:119], v[64:79]
    v_max3_u32 v203, v203, v4, v5
    v_max3_u32 v203, v203, v6, v0
    v_cmp_eq_u32 vcc, -1, v203
    v_mfma_f32_32x32x16_bf16 v[16:31], a[240:243], a[112:115], v[16:31]
    s_cbranch_vccnz L_rt_b15
L_ok_b15:
    s_waitcnt vmcnt(7)
    v_mfma_f32_32x32x16_bf16 v[32:47], a[252:255], a[120:123], v[32:47]
    s_add_u32 s69, s64, 5242880
    buffer_load_dwordx4 v[112:115], v15, s[16:19], s69 offen sc1
    buffer_load_dwordx4 v[116:119], v7, s[16:19], s69 offen sc1
    v_max3_u32 v203, v80, v81, v82
    v_max_u32 v203, v203, v83
    v_max3_u32 v203, v203, v84, v85
    v_max3_u32 v203, v203, v86, v87
    v_cmp_eq_u32 vcc, -1, v203
    v_mfma_f32_32x32x16_bf16 v[48:63], a[248:251], a[124:127], v[48:63]
    v_mfma_f32_32x32x16_bf16 v[64:79], a[252:255], a[124:127], v[64:79]
    v_mfma_f32_32x32x16_bf16 v[16:31], a[248:251], a[120:123], v[16:31]
    s_cbranch_vccnz L_rt_b16
L_ok_b16:
    s_waitcnt vmcnt(6)
    v_mfma_f32_32x32x16_bf16 v[32:47], v[212:215], v[80:83], v[32:47]
    s_add_u32 s69, s65, 5242880
    buffer_load_dwordx4 v[120:123], v15, s[16:19], s69 offen sc1
    buffer_load_dwordx4 v[124:127], v7, s[16:19], s69 offen sc1
    v_max3_u32 v203, v88, v89, v90
    v_max_u32 v203, v203, v91
    v_max3_u32 v203, v203, v92, v93
    v_max3_u32 v203, v203, v94, v95
    v_cmp_eq_u32 vcc, -1, v203
    v_mfma_f32_32x32x16_bf16 v[48:63], v[208:211], v[84:87], v[48:63]
    v_mfma_f32_32x32x16_bf16 v[64:79], v[212:215], v[84:87], v[64:79]
    v_mfma_f32_32x32x16_bf16 v[16:31], v[208:211], v[80:83], v[16:31]
    s_cbranch_vccnz L_rt_b17
L_ok_b17:
    s_waitcnt vmcnt(6)
    v_mfma_f32_32x32x16_bf16 v[32:47], v[220:223], v[88:91], v[32:47]
    s_add_u32 s69, s66, 5242880
    buffer_load_dwordx4 a[0:3], v15, s[16:19], s69 offen sc1
    buffer_load_dwordx4 a[4:7], v7, s[16:19], s69 offen sc1
    v_max3_u32 v203, v96, v97, v98
    v_max_u32 v203, v203, v99
    v_max3_u32 v203, v203, v100, v101
    v_max3_u32 v203, v203, v102, v103
    v_cmp_eq_u32 vcc, -1, v203
    v_mfma_f32_32x32x16_bf16 v[48:63], v[216:219], v[92:95], v[48:63]
    v_mfma_f32_32x32x16_bf16 v[64:79], v[220:223], v[92:95], v[64:79]
    v_mfma_f32_32x32x16_bf16 v[16:31], v[216:219], v[88:91], v[16:31]
    s_cbranch_vccnz L_rt_b18
L_ok_b18:
    s_waitcnt vmcnt(6)
    v_mfma_f32_32x32x16_bf16 v[32:47], v[228:231], v[96:99], v[32:47]
    s_add_u32 s69, s67, 5242880
    buffer_load_dwordx4 a[8:11], v15, s[16:19], s69 offen sc1
    buffer_load_dwordx4 a[12:15], v7, s[16:19], s69 offen sc1
    v_max3_u32 v203, v104, v105, v106
    v_max_u32 v203, v203, v107
    v_max3_u32 v203, v203, v108, v109
    v_max3_u32 v203, v203, v110, v111
    v_cmp_eq_u32 vcc, -1, v203
    v_mfma_f32_32x32x16_bf16 v[48:63], v[224:227], v[100:103], v[48:63]
    v_mfma_f32_32x32x16_bf16 v[64:79], v[228:231], v[100:103], v[64:79]
    v_mfma_f32_32x32x16_bf16 v[16:31], v[224:227], v[96:99], v[16:31]
    s_cbranch_vccnz L_rt_b19
L_ok_b19:
    s_waitcnt vmcnt(6)
    v_mfma_f32_32x32x16_bf16 v[32:47], v[236:239], v[104:107], v[32:47]
    s_add_u32 s69, s64, 6291456
    buffer_load_dwordx4 a[16:19], v15, s[16:19], s69 offen sc1
    buffer_load_dwordx4 a[20:23], v7, s[16:19], s69 offen sc1
    v_max3_u32 v203, v112, v113, v114
    v_max_u32 v203, v203, v115
    v_max3_u32 v203, v203, v116, v117
    v_max3_u32 v203, v203, v118, v119
    v_cmp_eq_u32 vcc, -1, v203
    v_mfma_f32_32x32x16_bf16 v[48:63], v[232:235], v[108:111], v[48:63]
    v_mfma_f32_32x32x16_bf16 v[64:79], v[236:239], v[108:111], v[64:79]
    v_mfma_f32_32x32x16_bf16 v[16:31], v[232:235], v[104:107], v[16:31]
    s_cbranch_vccnz L_rt_b20
L_ok_b20:
    s_waitcnt vmcnt(6)
    v_mfma_f32_32x32x16_bf16 v[32:47], v[244:247], v[112:115], v[32:47]
    s_add_u32 s69, s65, 6291456
    buffer_load_dwordx4 a[24:27], v15, s[16:19], s69 offen sc1
    buffer_load_dwordx4 a[28:31], v7, s[16:19], s69 offen sc1
    v_max3_u32 v203, v120, v121, v122
    v_max_u32 v203, v203, v123
    v_max3_u32 v203, v203, v124, v125
    v_max3_u32 v203, v203, v126, v127
    v_cmp_eq_u32 vcc, -1, v203
    v_mfma_f32_32x32x16_bf16 v[48:63], v[240:243], v[116:119], v[48:63]
    v_mfma_f32_32x32x16_bf16 v[64:79], v[244:247], v[116:119], v[64:79]
    v_mfma_f32_32x32x16_bf16 v[16:31], v[240:243], v[112:115], v[16:31]
    s_cbranch_vccnz L_rt_b21
L_ok_b21:
    s_waitcnt vmcnt(6)
    v_mfma_f32_32x32x16_bf16 v[32:47], v[252:255], v[120:123], v[32:47]
    s_add_u32 s69, s66, 6291456
    buffer_load_dwordx4 a[32:35], v15, s[16:19], s69 offen sc1
    buffer_load_dwordx4 a[36:39], v7, s[16:19], s69 offen sc1
    v_accvgpr_read_b32 v4, a0
    v_accvgpr_read_b32 v5, a1
    v_accvgpr_read_b32 v6, a2
    v_accvgpr_read_b32 v0, a3
    v_max3_u32 v203, v4, v5, v6
    v_mfma_f32_32x32x16_bf16 v[48:63], v[248:251], v[124:127], v[48:63]
    v_max_u32 v203, v203, v0
    v_accvgpr_read_b32 v4, a4
    v_accvgpr_read_b32 v5, a5
    v_accvgpr_read_b32 v6, a6
    v_accvgpr_read_b32 v0, a7
    v_mfma_f32_32x32x16_bf16 v[64:79], v[252:255], v[124:127], v[64:79]
    v_max3_u32 v203, v203, v4, v5
    v_max3_u32 v203, v203, v6, v0
    v_cmp_eq_u32 vcc, -1, v203
    v_mfma_f32_32x32x16_bf16 v[16:31], v[248:251], v[120:123], v[16:31]
    s_cbranch_vccnz L_rt_b22
L_ok_b22:
    s_waitcnt vmcnt(6)
    v_mfma_f32_32x32x16_bf16 v[32:47], v[132:135], a[0:3], v[32:47]
    s_add_u32 s69, s67, 6291456
    buffer_load_dwordx4 a[40:43], v15, s[16:19], s69 offen sc1
    buffer_load_dwordx4 a[44:47], v7, s[16:19], s69 offen sc1
    v_accvgpr_read_b32 v4, a8
    v_accvgpr_read_b32 v5, a9
    v_accvgpr_read_b32 v6, a10
    v_accvgpr_read_b32 v0, a11
    v_max3_u32 v203, v4, v5, v6
    v_mfma_f32_32x32x16_bf16 v[48:63], v[128:131], a[4:7], v[48:63]
    v_max_u32 v203, v203, v0
    v_accvgpr_read_b32 v4, a12
    v_accvgpr_read_b32 v5, a13
    v_accvgpr_read_b32 v6, a14
    v_accvgpr_read_b32 v0, a15
    v_mfma_f32_32x32x16_bf16 v[64:79], v[132:135], a[4:7], v[64:79]
    v_max3_u32 v203, v203, v4, v5
    v_max3_u32 v203, v203, v6, v0
    v_cmp_eq_u32 vcc, -1, v203
    v_mfma_f32_32x32x16_bf16 v[16:31], v[128:131], a[0:3], v[16:31]
    s_cbranch_vccnz L_rt_b23
L_ok_b23:
    s_waitcnt vmcnt(6)
    v_mfma_f32_32x32x16_bf16 v[32:47], v[140:143], a[8:11], v[32:47]
    v_accvgpr_read_b32 v4, a16
    v_accvgpr_read_b32 v5, a17
    v_accvgpr_read_b32 v6, a18
    v_accvgpr_read_b32 v0, a19
    v_max3_u32 v203, v4, v5, v6
    v_mfma_f32_32x32x16_bf16 v[48:63], v[136:139], a[12:15], v[48:63]
    v_max_u32 v203, v203, v0
    v_accvgpr_read_b32 v4, a20
    v_accvgpr_read_b32 v5, a21
    v_accvgpr_read_b32 v6, a22
    v_accvgpr_read_b32 v0, a23
    v_mfma_f32_32x32x16_bf16 v[64:79], v[140:143], a[12:15], v[64:79]
    v_max3_u32 v203, v203, v4, v5
    v_max3_u32 v203, v203, v6, v0
    v_cmp_eq_u32 vcc, -1, v203
    v_mfma_f32_32x32x16_bf16 v[16:31], v[136:139], a[8:11], v[16:31]
    s_cbranch_vccnz L_rt_b24
L_ok_b24:
    s_waitcnt vmcnt(4)
    v_mfma_f32_32x32x16_bf16 v[32:47], v[148:151], a[16:19], v[32:47]
    v_accvgpr_read_b32 v4, a24
    v_accvgpr_read_b32 v5, a25
    v_accvgpr_read_b32 v6, a26
    v_accvgpr_read_b32 v0, a27
    v_max3_u32 v203, v4, v5, v6
    v_mfma_f32_32x32x16_bf16 v[48:63], v[144:147], a[20:23], v[48:63]
    v_max_u32 v203, v203, v0
    v_accvgpr_read_b32 v4, a28
    v_accvgpr_read_b32 v5, a29
    v_accvgpr_read_b32 v6, a30
    v_accvgpr_read_b32 v0, a31
    v_mfma_f32_32x32x16_bf16 v[64:79], v[148:151], a[20:23], v[64:79]
    v_max3_u32 v203, v203, v4, v5
    v_max3_u32 v203, v203, v6, v0
    v_cmp_eq_u32 vcc, -1, v203
    v_mfma_f32_32x32x16_bf16 v[16:31], v[144:147], a[16:19], v[16:31]
    s_cbranch_vccnz L_rt_b25
L_ok_b25:
    s_waitcnt vmcnt(2)
    v_mfma_f32_32x32x16_bf16 v[32:47], v[156:159], a[24:27], v[32:47]
    v_accvgpr_read_b32 v4, a32
    v_accvgpr_read_b32 v5, a33
    v_accvgpr_read_b32 v6, a34
    v_accvgpr_read_b32 v0, a35
    v_max3_u32 v203, v4, v5, v6
    v_mfma_f32_32x32x16_bf16 v[48:63], v[152:155], a[28:31], v[48:63]
    v_max_u32 v203, v203, v0
    v_accvgpr_read_b32 v4, a36
    v_accvgpr_read_b32 v5, a37
    v_accvgpr_read_b32 v6, a38
    v_accvgpr_read_b32 v0, a39
    v_mfma_f32_32x32x16_bf16 v[64:79], v[156:159], a[28:31], v[64:79]
    v_max3_u32 v203, v203, v4, v5
    v_max3_u32 v203, v203, v6, v0
    v_cmp_eq_u32 vcc, -1, v203
    v_mfma_f32_32x32x16_bf16 v[16:31], v[152:155], a[24:27], v[16:31]
    s_cbranch_vccnz L_rt_b26
L_ok_b26:
    s_waitcnt vmcnt(0)
    v_mfma_f32_32x32x16_bf16 v[32:47], v[180:183], a[32:35], v[32:47]
    v_accvgpr_read_b32 v4, a40
    v_accvgpr_read_b32 v5, a41
    v_accvgpr_read_b32 v6, a42
    v_accvgpr_read_b32 v0, a43
    v_max3_u32 v203, v4, v5, v6
    v_mfma_f32_32x32x16_bf16 v[48:63], v[176:179], a[36:39], v[48:63]
    v_max_u32 v203, v203, v0
    v_accvgpr_read_b32 v4, a44
    v_accvgpr_read_b32 v5, a45
    v_accvgpr_read_b32 v6, a46
    v_accvgpr_read_b32 v0, a47
    v_mfma_f32_32x32x16_bf16 v[64:79], v[180:183], a[36:39], v[64:79]
    v_max3_u32 v203, v203, v4, v5
    v_max3_u32 v203, v203, v6, v0
    v_cmp_eq_u32 vcc, -1, v203
    v_mfma_f32_32x32x16_bf16 v[16:31], v[176:179], a[32:35], v[16:31]
    s_cbranch_vccnz L_rt_b27
L_ok_b27:
    v_mfma_f32_32x32x16_bf16 v[32:47], v[188:191], a[40:43], v[32:47]
    v_mfma_f32_32x32x16_bf16 v[48:63], v[184:187], a[44:47], v[48:63]
    v_mfma_f32_32x32x16_bf16 v[64:79], v[188:191], a[44:47], v[64:79]
    v_mfma_f32_32x32x16_bf16 v[16:31], v[184:187], a[40:43], v[16:31]
    s_xor_b32 s29, s20, 1
    s_mul_i32 s29, s29, 12288
    s_add_u32 s29, s29, 0
    v_add_u32 v161, s29, v2
    s_xor_b32 s29, s20, 2
    s_mul_i32 s29, s29, 12288
    s_add_u32 s29, s29, 4096
    v_add_u32 v162, s29, v2
    s_xor_b32 s29, s20, 3
    s_mul_i32 s29, s29, 12288
    s_add_u32 s29, s29, 8192
    v_add_u32 v163, s29, v2
    s_mul_i32 s29, s20, 12288
    s_add_u32 s29, s29, 0
    v_add_u32 v160, s29, v2
    v_and_b32 v164, 31, v1
    v_lshlrev_b32 v164, 10, v164
    v_lshrrev_b32 v165, 5, v1
    v_lshl_add_u32 v164, v165, 4, v164
    s_lshl_b32 s29, s49, 15
    s_lshl_b32 s30, s48, 6
    s_add_u32 s29, s29, s30
    ds_write_b128 v161, v[32:35] offset:0
    ds_write_b128 v161, v[36:39] offset:1024
    ds_write_b128 v161, v[40:43] offset:2048
    ds_write_b128 v161, v[44:47] offset:3072
    ds_write_b128 v162, v[48:51] offset:0
    ds_write_b128 v162, v[52:55] offset:1024
    ds_write_b128 v162, v[56:59] offset:2048
    ds_write_b128 v162, v[60:63] offset:3072
    ds_write_b128 v163, v[64:67] offset:0
    ds_write_b128 v163, v[68:71] offset:1024
    ds_write_b128 v163, v[72:75] offset:2048
    ds_write_b128 v163, v[76:79] offset:3072
    v_lshlrev_b32 v128, 16, v204
    v_and_b32 v129, 0xffff0000, v204
    v_lshlrev_b32 v130, 16, v205
    v_and_b32 v131, 0xffff0000, v205
    v_lshlrev_b32 v132, 16, v206
    v_and_b32 v133, 0xffff0000, v206
    v_lshlrev_b32 v134, 16, v207
    v_and_b32 v135, 0xffff0000, v207
    v_lshlrev_b32 v136, 16, v8
    v_and_b32 v137, 0xffff0000, v8
    v_lshlrev_b32 v138, 16, v9
    v_and_b32 v139, 0xffff0000, v9
    v_lshlrev_b32 v140, 16, v10
    v_and_b32 v141, 0xffff0000, v10
    v_lshlrev_b32 v142, 16, v11
    v_and_b32 v143, 0xffff0000, v11
    v_add_f32 v128, v128, v16
    v_add_f32 v129, v129, v17
    v_add_f32 v130, v130, v18
    v_add_f32 v131, v131, v19
    v_add_f32 v132, v132, v20
    v_add_f32 v133, v133, v21
    v_add_f32 v134, v134, v22
    v_add_f32 v135, v135, v23
    v_add_f32 v136, v136, v24
    v_add_f32 v137, v137, v25
    v_add_f32 v138, v138, v26
    v_add_f32 v139, v139, v27
    v_add_f32 v140, v140, v28
    v_add_f32 v141, v141, v29
    v_add_f32 v142, v142, v30
    v_add_f32 v143, v143, v31
    s_waitcnt lgkmcnt(0)
    s_barrier
    ds_read_b128 v[80:83], v160 offset:0
    ds_read_b128 v[96:99], v160 offset:4096
    ds_read_b128 v[112:115], v160 offset:8192
    ds_read_b128 v[84:87], v160 offset:1024
    ds_read_b128 v[100:103], v160 offset:5120
    ds_read_b128 v[116:119], v160 offset:9216
    ds_read_b128 v[88:91], v160 offset:2048
    ds_read_b128 v[104:107], v160 offset:6144
    ds_read_b128 v[120:123], v160 offset:10240
    ds_read_b128 v[92:95], v160 offset:3072
    ds_read_b128 v[108:111], v160 offset:7168
    ds_read_b128 v[124:127], v160 offset:11264
    s_waitcnt lgkmcnt(9)
    v_add_f32 v80, v80, v96
    v_add_f32 v128, v128, v112
    v_add_f32 v81, v81, v97
    v_add_f32 v129, v129, v113
    v_add_f32 v82, v82, v98
    v_add_f32 v130, v130, v114
    v_add_f32 v83, v83, v99
    v_add_f32 v131, v131, v115
    v_add_f32 v128, v128, v80
    v_add_f32 v129, v129, v81
    v_add_f32 v130, v130, v82
    v_add_f32 v131, v131, v83
    v_cvt_pk_bf16_f32 v144, v128, v129
    v_cvt_pk_bf16_f32 v145, v130, v131
    s_waitcnt lgkmcnt(6)
    v_add_f32 v84, v84, v100
    v_add_f32 v132, v132, v116
    v_add_f32 v85, v85, v101
    v_add_f32 v133, v133, v117
    v_add_f32 v86, v86, v102
    v_add_f32 v134, v134, v118
    v_add_f32 v87, v87, v103
    v_add_f32 v135, v135, v119
    v_add_f32 v132, v132, v84
    v_add_f32 v133, v133, v85
    v_add_f32 v134, v134, v86
    v_add_f32 v135, v135, v87
    v_cvt_pk_bf16_f32 v146, v132, v133
    v_cvt_pk_bf16_f32 v147, v134, v135
    s_nop 0
    v_permlane32_swap_b32 v144, v146
    v_permlane32_swap_b32 v145, v147
    buffer_store_dwordx4 v[144:147], v164, s[8:11], s29 offen offset:0
    s_waitcnt lgkmcnt(3)
    v_add_f32 v88, v88, v104
    v_add_f32 v136, v136, v120
    v_add_f32 v89, v89, v105
    v_add_f32 v137, v137, v121
    v_add_f32 v90, v90, v106
    v_add_f32 v138, v138, v122
    v_add_f32 v91, v91, v107
    v_add_f32 v139, v139, v123
    v_add_f32 v136, v136, v88
    v_add_f32 v137, v137, v89
    v_add_f32 v138, v138, v90
    v_add_f32 v139, v139, v91
    v_cvt_pk_bf16_f32 v148, v136, v137
    v_cvt_pk_bf16_f32 v149, v138, v139
    s_waitcnt lgkmcnt(0)
    v_add_f32 v92, v92, v108
    v_add_f32 v140, v140, v124
    v_add_f32 v93, v93, v109
    v_add_f32 v141, v141, v125
    v_add_f32 v94, v94, v110
    v_add_f32 v142, v142, v126
    v_add_f32 v95, v95, v111
    v_add_f32 v143, v143, v127
    v_add_f32 v140, v140, v92
    v_add_f32 v141, v141, v93
    v_add_f32 v142, v142, v94
    v_add_f32 v143, v143, v95
    v_cvt_pk_bf16_f32 v150, v140, v141
    v_cvt_pk_bf16_f32 v151, v142, v143
    s_nop 0
    v_permlane32_swap_b32 v148, v150
    v_permlane32_swap_b32 v149, v151
    buffer_store_dwordx4 v[148:151], v164, s[8:11], s29 offen offset:32
L_k4_end:
    s_endpgm
L_rt_h0:
    s_add_u32 s39, s39, 1
    s_cmp_ge_u32 s39, 0x40000
    s_cbranch_scc1 L_ok_h0
    s_sleep 2
    buffer_load_dwordx4 a[0:3], v3, s[16:19], s40 offen offset:0 sc1
    s_waitcnt vmcnt(0)
    v_accvgpr_read_b32 v4, a0
    v_accvgpr_read_b32 v5, a1
    v_accvgpr_read_b32 v6, a2
    v_accvgpr_read_b32 v0, a3
    v_max3_u32 v203, v4, v5, v6
    v_max_u32 v203, v203, v0
    v_cmp_eq_u32 vcc, -1, v203
    s_nop 3
    s_cbranch_vccnz L_rt_h0
    s_branch L_ok_h0
L_rt_h1:
    s_add_u32 s39, s39, 1
    s_cmp_ge_u32 s39, 0x40000
    s_cbranch_scc1 L_ok_h1
    s_sleep 2
    buffer_load_dwordx4 a[4:7], v3, s[16:19], s40 offen offset:1024 sc1
    s_waitcnt vmcnt(0)
    v_accvgpr_read_b32 v4, a4
    v_accvgpr_read_b32 v5, a5
    v_accvgpr_read_b32 v6, a6
    v_accvgpr_read_b32 v0, a7
    v_max3_u32 v203, v4, v5, v6
    v_max_u32 v203, v203, v0
    v_cmp_eq_u32 vcc, -1, v203
    s_nop 3
    s_cbranch_vccnz L_rt_h1
    s_branch L_ok_h1
L_rt_h2:
    s_add_u32 s39, s39, 1
    s_cmp_ge_u32 s39, 0x40000
    s_cbranch_scc1 L_ok_h2
    s_sleep 2
    buffer_load_dwordx4 a[8:11], v3, s[16:19], s40 offen offset:2048 sc1
    s_waitcnt vmcnt(0)
    v_accvgpr_read_b32 v4, a8
    v_accvgpr_read_b32 v5, a9
    v_accvgpr_read_b32 v6, a10
    v_accvgpr_read_b32 v0, a11
    v_max3_u32 v203, v4, v5, v6
    v_max_u32 v203, v203, v0
    v_cmp_eq_u32 vcc, -1, v203
    s_nop 3
    s_cbranch_vccnz L_rt_h2
    s_branch L_ok_h2
L_rt_h3:
    s_add_u32 s39, s39, 1
    s_cmp_ge_u32 s39, 0x40000
    s_cbranch_scc1 L_ok_h3
    s_sleep 2
    buffer_load_dwordx4 a[12:15], v3, s[16:19], s40 offen offset:3072 sc1
    s_waitcnt vmcnt(0)
    v_accvgpr_read_b32 v4, a12
    v_accvgpr_read_b32 v5, a13
    v_accvgpr_read_b32 v6, a14
    v_accvgpr_read_b32 v0, a15
    v_max3_u32 v203, v4, v5, v6
    v_max_u32 v203, v203, v0
    v_cmp_eq_u32 vcc, -1, v203
    s_nop 3
    s_cbranch_vccnz L_rt_h3
    s_branch L_ok_h3
L_rt_h4:
    s_add_u32 s39, s39, 1
    s_cmp_ge_u32 s39, 0x40000
    s_cbranch_scc1 L_ok_h4
    s_sleep 2
    buffer_load_dwordx4 a[16:19], v3, s[16:19], s41 offen offset:0 sc1
    s_waitcnt vmcnt(0)
    v_accvgpr_read_b32 v4, a16
    v_accvgpr_read_b32 v5, a17
    v_accvgpr_read_b32 v6, a18
    v_accvgpr_read_b32 v0, a19
    v_max3_u32 v203, v4, v5, v6
    v_max_u32 v203, v203, v0
    v_cmp_eq_u32 vcc, -1, v203
    s_nop 3
    s_cbranch_vccnz L_rt_h4
    s_branch L_ok_h4
L_rt_h5:
    s_add_u32 s39, s39, 1
    s_cmp_ge_u32 s39, 0x40000
    s_cbranch_scc1 L_ok_h5
    s_sleep 2
    buffer_load_dwordx4 a[20:23], v3, s[16:19], s41 offen offset:1024 sc1
    s_waitcnt vmcnt(0)
    v_accvgpr_read_b32 v4, a20
    v_accvgpr_read_b32 v5, a21
    v_accvgpr_read_b32 v6, a22
    v_accvgpr_read_b32 v0, a23
    v_max3_u32 v203, v4, v5, v6
    v_max_u32 v203, v203, v0
    v_cmp_eq_u32 vcc, -1, v203
    s_nop 3
    s_cbranch_vccnz L_rt_h5
    s_branch L_ok_h5
L_rt_h6:
    s_add_u32 s39, s39, 1
    s_cmp_ge_u32 s39, 0x40000
    s_cbranch_scc1 L_ok_h6
    s_sleep 2
    buffer_load_dwordx4 a[24:27], v3, s[16:19], s41 offen offset:2048 sc1
    s_waitcnt vmcnt(0)
    v_accvgpr_read_b32 v4, a24
    v_accvgpr_read_b32 v5, a25
    v_accvgpr_read_b32 v6, a26
    v_accvgpr_read_b32 v0, a27
    v_max3_u32 v203, v4, v5, v6
    v_max_u32 v203, v203, v0
    v_cmp_eq_u32 vcc, -1, v203
    s_nop 3
    s_cbranch_vccnz L_rt_h6
    s_branch L_ok_h6
L_rt_h7:
    s_add_u32 s39, s39, 1
    s_cmp_ge_u32 s39, 0x40000
    s_cbranch_scc1 L_ok_h7
    s_sleep 2
    buffer_load_dwordx4 a[28:31], v3, s[16:19], s41 offen offset:3072 sc1
    s_waitcnt vmcnt(0)
    v_accvgpr_read_b32 v4, a28
    v_accvgpr_read_b32 v5, a29
    v_accvgpr_read_b32 v6, a30
    v_accvgpr_read_b32 v0, a31
    v_max3_u32 v203, v4, v5, v6
    v_max_u32 v203, v203, v0
    v_cmp_eq_u32 vcc, -1, v203
    s_nop 3
    s_cbranch_vccnz L_rt_h7
    s_branch L_ok_h7
L_rt_h8:
    s_add_u32 s39, s39, 1
    s_cmp_ge_u32 s39, 0x40000
    s_cbranch_scc1 L_ok_h8
    s_sleep 2
    buffer_load_dwordx4 a[32:35], v3, s[16:19], s42 offen offset:0 sc1
    s_waitcnt vmcnt(0)
    v_accvgpr_read_b32 v4, a32
    v_accvgpr_read_b32 v5, a33
    v_accvgpr_read_b32 v6, a34
    v_accvgpr_read_b32 v0, a35
    v_max3_u32 v203, v4, v5, v6
    v_max_u32 v203, v203, v0
    v_cmp_eq_u32 vcc, -1, v203
    s_nop 3
    s_cbranch_vccnz L_rt_h8
    s_branch L_ok_h8
L_rt_h9:
    s_add_u32 s39, s39, 1
    s_cmp_ge_u32 s39, 0x40000
    s_cbranch_scc1 L_ok_h9
    s_sleep 2
    buffer_load_dwordx4 a[36:39], v3, s[16:19], s42 offen offset:1024 sc1
    s_waitcnt vmcnt(0)
    v_accvgpr_read_b32 v4, a36
    v_accvgpr_read_b32 v5, a37
    v_accvgpr_read_b32 v6, a38
    v_accvgpr_read_b32 v0, a39
    v_max3_u32 v203, v4, v5, v6
    v_max_u32 v203, v203, v0
    v_cmp_eq_u32 vcc, -1, v203
    s_nop 3
    s_cbranch_vccnz L_rt_h9
    s_branch L_ok_h9
L_rt_h10:
    s_add_u32 s39, s39, 1
    s_cmp_ge_u32 s39, 0x40000
    s_cbranch_scc1 L_ok_h10
    s_sleep 2
    buffer_load_dwordx4 a[40:43], v3, s[16:19], s42 offen offset:2048 sc1
    s_waitcnt vmcnt(0)
    v_accvgpr_read_b32 v4, a40
    v_accvgpr_read_b32 v5, a41
    v_accvgpr_read_b32 v6, a42
    v_accvgpr_read_b32 v0, a43
    v_max3_u32 v203, v4, v5, v6
    v_max_u32 v203, v203, v0
    v_cmp_eq_u32 vcc, -1, v203
    s_nop 3
    s_cbranch_vccnz L_rt_h10
    s_branch L_ok_h10
L_rt_h11:
    s_add_u32 s39, s39, 1
    s_cmp_ge_u32 s39, 0x40000
    s_cbranch_scc1 L_ok_h11
    s_sleep 2
    buffer_load_dwordx4 a[44:47], v3, s[16:19], s42 offen offset:3072 sc1
    s_waitcnt vmcnt(0)
    v_accvgpr_read_b32 v4, a44
    v_accvgpr_read_b32 v5, a45
    v_accvgpr_read_b32 v6, a46
    v_accvgpr_read_b32 v0, a47
    v_max3_u32 v203, v4, v5, v6
    v_max_u32 v203, v203, v0
    v_cmp_eq_u32 vcc, -1, v203
    s_nop 3
    s_cbranch_vccnz L_rt_h11
    s_branch L_ok_h11
L_rt_h12:
    s_add_u32 s39, s39, 1
    s_cmp_ge_u32 s39, 0x40000
    s_cbranch_scc1 L_ok_h12
    s_sleep 2
    buffer_load_dwordx4 a[48:51], v3, s[16:19], s43 offen offset:0 sc1
    s_waitcnt vmcnt(0)
    v_accvgpr_read_b32 v4, a48
    v_accvgpr_read_b32 v5, a49
    v_accvgpr_read_b32 v6, a50
    v_accvgpr_read_b32 v0, a51
    v_max3_u32 v203, v4, v5, v6
    v_max_u32 v203, v203, v0
    v_cmp_eq_u32 vcc, -1, v203
    s_nop 3
    s_cbranch_vccnz L_rt_h12
    s_branch L_ok_h12
L_rt_h13:
    s_add_u32 s39, s39, 1
    s_cmp_ge_u32 s39, 0x40000
    s_cbranch_scc1 L_ok_h13
    s_sleep 2
    buffer_load_dwordx4 a[52:55], v3, s[16:19], s43 offen offset:1024 sc1
    s_waitcnt vmcnt(0)
    v_accvgpr_read_b32 v4, a52
    v_accvgpr_read_b32 v5, a53
    v_accvgpr_read_b32 v6, a54
    v_accvgpr_read_b32 v0, a55
    v_max3_u32 v203, v4, v5, v6
    v_max_u32 v203, v203, v0
    v_cmp_eq_u32 vcc, -1, v203
    s_nop 3
    s_cbranch_vccnz L_rt_h13
    s_branch L_ok_h13
L_rt_h14:
    s_add_u32 s39, s39, 1
    s_cmp_ge_u32 s39, 0x40000
    s_cbranch_scc1 L_ok_h14
    s_sleep 2
    buffer_load_dwordx4 a[56:59], v3, s[16:19], s43 offen offset:2048 sc1
    s_waitcnt vmcnt(0)
    v_accvgpr_read_b32 v4, a56
    v_accvgpr_read_b32 v5, a57
    v_accvgpr_read_b32 v6, a58
    v_accvgpr_read_b32 v0, a59
    v_max3_u32 v203, v4, v5, v6
    v_max_u32 v203, v203, v0
    v_cmp_eq_u32 vcc, -1, v203
    s_nop 3
    s_cbranch_vccnz L_rt_h14
    s_branch L_ok_h14
L_rt_h15:
    s_add_u32 s39, s39, 1
    s_cmp_ge_u32 s39, 0x40000
    s_cbranch_scc1 L_ok_h15
    s_sleep 2
    buffer_load_dwordx4 a[60:63], v3, s[16:19], s43 offen offset:3072 sc1
    s_waitcnt vmcnt(0)
    v_accvgpr_read_b32 v4, a60
    v_accvgpr_read_b32 v5, a61
    v_accvgpr_read_b32 v6, a62
    v_accvgpr_read_b32 v0, a63
    v_max3_u32 v203, v4, v5, v6
    v_max_u32 v203, v203, v0
    v_cmp_eq_u32 vcc, -1, v203
    s_nop 3
    s_cbranch_vccnz L_rt_h15
    s_branch L_ok_h15
L_rt_h16:
    s_add_u32 s39, s39, 1
    s_cmp_ge_u32 s39, 0x40000
    s_cbranch_scc1 L_ok_h16
    s_sleep 2
    buffer_load_dwordx4 a[64:67], v3, s[16:19], s44 offen offset:0 sc1
    s_waitcnt vmcnt(0)
    v_accvgpr_read_b32 v4, a64
    v_accvgpr_read_b32 v5, a65
    v_accvgpr_read_b32 v6, a66
    v_accvgpr_read_b32 v0, a67
    v_max3_u32 v203, v4, v5, v6
    v_max_u32 v203, v203, v0
    v_cmp_eq_u32 vcc, -1, v203
    s_nop 3
    s_cbranch_vccnz L_rt_h16
    s_branch L_ok_h16
L_rt_h17:
    s_add_u32 s39, s39, 1
    s_cmp_ge_u32 s39, 0x40000
    s_cbranch_scc1 L_ok_h17
    s_sleep 2
    buffer_load_dwordx4 a[68:71], v3, s[16:19], s44 offen offset:1024 sc1
    s_waitcnt vmcnt(0)
    v_accvgpr_read_b32 v4, a68
    v_accvgpr_read_b32 v5, a69
    v_accvgpr_read_b32 v6, a70
    v_accvgpr_read_b32 v0, a71
    v_max3_u32 v203, v4, v5, v6
    v_max_u32 v203, v203, v0
    v_cmp_eq_u32 vcc, -1, v203
    s_nop 3
    s_cbranch_vccnz L_rt_h17
    s_branch L_ok_h17
L_rt_h18:
    s_add_u32 s39, s39, 1
    s_cmp_ge_u32 s39, 0x40000
    s_cbranch_scc1 L_ok_h18
    s_sleep 2
    buffer_load_dwordx4 a[72:75], v3, s[16:19], s44 offen offset:2048 sc1
    s_waitcnt vmcnt(0)
    v_accvgpr_read_b32 v4, a72
    v_accvgpr_read_b32 v5, a73
    v_accvgpr_read_b32 v6, a74
    v_accvgpr_read_b32 v0, a75
    v_max3_u32 v203, v4, v5, v6
    v_max_u32 v203, v203, v0
    v_cmp_eq_u32 vcc, -1, v203
    s_nop 3
    s_cbranch_vccnz L_rt_h18
    s_branch L_ok_h18
L_rt_h19:
    s_add_u32 s39, s39, 1
    s_cmp_ge_u32 s39, 0x40000
    s_cbranch_scc1 L_ok_h19
    s_sleep 2
    buffer_load_dwordx4 a[76:79], v3, s[16:19], s44 offen offset:3072 sc1
    s_waitcnt vmcnt(0)
    v_accvgpr_read_b32 v4, a76
    v_accvgpr_read_b32 v5, a77
    v_accvgpr_read_b32 v6, a78
    v_accvgpr_read_b32 v0, a79
    v_max3_u32 v203, v4, v5, v6
    v_max_u32 v203, v203, v0
    v_cmp_eq_u32 vcc, -1, v203
    s_nop 3
    s_cbranch_vccnz L_rt_h19
    s_branch L_ok_h19
L_rt_h20:
    s_add_u32 s39, s39, 1
    s_cmp_ge_u32 s39, 0x40000
    s_cbranch_scc1 L_ok_h20
    s_sleep 2
    buffer_load_dwordx4 a[80:83], v3, s[16:19], s45 offen offset:0 sc1
    s_waitcnt vmcnt(0)
    v_accvgpr_read_b32 v4, a80
    v_accvgpr_read_b32 v5, a81
    v_accvgpr_read_b32 v6, a82
    v_accvgpr_read_b32 v0, a83
    v_max3_u32 v203, v4, v5, v6
    v_max_u32 v203, v203, v0
    v_cmp_eq_u32 vcc, -1, v203
    s_nop 3
    s_cbranch_vccnz L_rt_h20
    s_branch L_ok_h20
L_rt_st:
    s_add_u32 s39, s39, 1
    s_cmp_ge_u32 s39, 0x40000
    s_cbranch_scc1 L_ok_st
    s_sleep 2
    buffer_load_dwordx4 v[176:179], v2, s[16:19], s52 offen offset:0 sc1
    buffer_load_dwordx4 v[180:183], v2, s[16:19], s52 offen offset:1024 sc1
    buffer_load_dwordx4 v[184:187], v2, s[16:19], s52 offen offset:2048 sc1
    buffer_load_dwordx4 v[188:191], v2, s[16:19], s52 offen offset:3072 sc1
    s_waitcnt vmcnt(0)
    v_max3_u32 v203, v176, v177, v178
    v_max_u32 v203, v203, v179
    v_max3_u32 v203, v203, v180, v181
    v_max3_u32 v203, v203, v182, v183
    v_max3_u32 v203, v203, v184, v185
    v_max3_u32 v203, v203, v186, v187
    v_max3_u32 v203, v203, v188, v189
    v_max3_u32 v203, v203, v190, v191
    v_cmp_eq_u32 vcc, -1, v203
    s_nop 3
    s_cbranch_vccnz L_rt_st
    s_branch L_ok_st
L_rt_h21:
    s_add_u32 s39, s39, 1
    s_cmp_ge_u32 s39, 0x40000
    s_cbranch_scc1 L_ok_h21
    s_sleep 2
    buffer_load_dwordx4 a[84:87], v3, s[16:19], s45 offen offset:1024 sc1
    s_waitcnt vmcnt(0)
    v_accvgpr_read_b32 v4, a84
    v_accvgpr_read_b32 v5, a85
    v_accvgpr_read_b32 v6, a86
    v_accvgpr_read_b32 v0, a87
    v_max3_u32 v203, v4, v5, v6
    v_max_u32 v203, v203, v0
    v_cmp_eq_u32 vcc, -1, v203
    s_nop 3
    s_cbranch_vccnz L_rt_h21
    s_branch L_ok_h21
L_rt_h22:
    s_add_u32 s39, s39, 1
    s_cmp_ge_u32 s39, 0x40000
    s_cbranch_scc1 L_ok_h22
    s_sleep 2
    buffer_load_dwordx4 a[88:91], v3, s[16:19], s45 offen offset:2048 sc1
    s_waitcnt vmcnt(0)
    v_accvgpr_read_b32 v4, a88
    v_accvgpr_read_b32 v5, a89
    v_accvgpr_read_b32 v6, a90
    v_accvgpr_read_b32 v0, a91
    v_max3_u32 v203, v4, v5, v6
    v_max_u32 v203, v203, v0
    v_cmp_eq_u32 vcc, -1, v203
    s_nop 3
    s_cbranch_vccnz L_rt_h22
    s_branch L_ok_h22
L_rt_h23:
    s_add_u32 s39, s39, 1
    s_cmp_ge_u32 s39, 0x40000
    s_cbranch_scc1 L_ok_h23
    s_sleep 2
    buffer_load_dwordx4 a[92:95], v3, s[16:19], s45 offen offset:3072 sc1
    s_waitcnt vmcnt(0)
    v_accvgpr_read_b32 v4, a92
    v_accvgpr_read_b32 v5, a93
    v_accvgpr_read_b32 v6, a94
    v_accvgpr_read_b32 v0, a95
    v_max3_u32 v203, v4, v5, v6
    v_max_u32 v203, v203, v0
    v_cmp_eq_u32 vcc, -1, v203
    s_nop 3
    s_cbranch_vccnz L_rt_h23
    s_branch L_ok_h23
L_rt_h24:
    s_add_u32 s39, s39, 1
    s_cmp_ge_u32 s39, 0x40000
    s_cbranch_scc1 L_ok_h24
    s_sleep 2
    buffer_load_dwordx4 a[96:99], v3, s[16:19], s46 offen offset:0 sc1
    s_waitcnt vmcnt(0)
    v_accvgpr_read_b32 v4, a96
    v_accvgpr_read_b32 v5, a97
    v_accvgpr_read_b32 v6, a98
    v_accvgpr_read_b32 v0, a99
    v_max3_u32 v203, v4, v5, v6
    v_max_u32 v203, v203, v0
    v_cmp_eq_u32 vcc, -1, v203
    s_nop 3
    s_cbranch_vccnz L_rt_h24
    s_branch L_ok_h24
L_rt_h25:
    s_add_u32 s39, s39, 1
    s_cmp_ge_u32 s39, 0x40000
    s_cbranch_scc1 L_ok_h25
    s_sleep 2
    buffer_load_dwordx4 a[100:103], v3, s[16:19], s46 offen offset:1024 sc1
    s_waitcnt vmcnt(0)
    v_accvgpr_read_b32 v4, a100
    v_accvgpr_read_b32 v5, a101
    v_accvgpr_read_b32 v6, a102
    v_accvgpr_read_b32 v0, a103
    v_max3_u32 v203, v4, v5, v6
    v_max_u32 v203, v203, v0
    v_cmp_eq_u32 vcc, -1, v203
    s_nop 3
    s_cbranch_vccnz L_rt_h25
    s_branch L_ok_h25
L_rt_h26:
    s_add_u32 s39, s39, 1
    s_cmp_ge_u32 s39, 0x40000
    s_cbranch_scc1 L_ok_h26
    s_sleep 2
    buffer_load_dwordx4 a[104:107], v3, s[16:19], s46 offen offset:2048 sc1
    s_waitcnt vmcnt(0)
    v_accvgpr_read_b32 v4, a104
    v_accvgpr_read_b32 v5, a105
    v_accvgpr_read_b32 v6, a106
    v_accvgpr_read_b32 v0, a107
    v_max3_u32 v203, v4, v5, v6
    v_max_u32 v203, v203, v0
    v_cmp_eq_u32 vcc, -1, v203
    s_nop 3
    s_cbranch_vccnz L_rt_h26
    s_branch L_ok_h26
L_rt_h27:
    s_add_u32 s39, s39, 1
    s_cmp_ge_u32 s39, 0x40000
    s_cbranch_scc1 L_ok_h27
    s_sleep 2
    buffer_load_dwordx4 a[108:111], v3, s[16:19], s46 offen offset:3072 sc1
    s_waitcnt vmcnt(0)
    v_accvgpr_read_b32 v4, a108
    v_accvgpr_read_b32 v5, a109
    v_accvgpr_read_b32 v6, a110
    v_accvgpr_read_b32 v0, a111
    v_max3_u32 v203, v4, v5, v6
    v_max_u32 v203, v203, v0
    v_cmp_eq_u32 vcc, -1, v203
    s_nop 3
    s_cbranch_vccnz L_rt_h27
    s_branch L_ok_h27
L_rt_h28:
    s_add_u32 s39, s39, 1
    s_cmp_ge_u32 s39, 0x40000
    s_cbranch_scc1 L_ok_h28
    s_sleep 2
    buffer_load_dwordx4 a[112:115], v3, s[16:19], s47 offen offset:0 sc1
    s_waitcnt vmcnt(0)
    v_accvgpr_read_b32 v4, a112
    v_accvgpr_read_b32 v5, a113
    v_accvgpr_read_b32 v6, a114
    v_accvgpr_read_b32 v0, a115
    v_max3_u32 v203, v4, v5, v6
    v_max_u32 v203, v203, v0
    v_cmp_eq_u32 vcc, -1, v203
    s_nop 3
    s_cbranch_vccnz L_rt_h28
    s_branch L_ok_h28
L_rt_h29:
    s_add_u32 s39, s39, 1
    s_cmp_ge_u32 s39, 0x40000
    s_cbranch_scc1 L_ok_h29
    s_sleep 2
    buffer_load_dwordx4 a[116:119], v3, s[16:19], s47 offen offset:1024 sc1
    s_waitcnt vmcnt(0)
    v_accvgpr_read_b32 v4, a116
    v_accvgpr_read_b32 v5, a117
    v_accvgpr_read_b32 v6, a118
    v_accvgpr_read_b32 v0, a119
    v_max3_u32 v203, v4, v5, v6
    v_max_u32 v203, v203, v0
    v_cmp_eq_u32 vcc, -1, v203
    s_nop 3
    s_cbranch_vccnz L_rt_h29
    s_branch L_ok_h29
L_rt_h30:
    s_add_u32 s39, s39, 1
    s_cmp_ge_u32 s39, 0x40000
    s_cbranch_scc1 L_ok_h30
    s_sleep 2
    buffer_load_dwordx4 a[120:123], v3, s[16:19], s47 offen offset:2048 sc1
    s_waitcnt vmcnt(0)
    v_accvgpr_read_b32 v4, a120
    v_accvgpr_read_b32 v5, a121
    v_accvgpr_read_b32 v6, a122
    v_accvgpr_read_b32 v0, a123
    v_max3_u32 v203, v4, v5, v6
    v_max_u32 v203, v203, v0
    v_cmp_eq_u32 vcc, -1, v203
    s_nop 3
    s_cbranch_vccnz L_rt_h30
    s_branch L_ok_h30
L_rt_h31:
    s_add_u32 s39, s39, 1
    s_cmp_ge_u32 s39, 0x40000
    s_cbranch_scc1 L_ok_h31
    s_sleep 2
    buffer_load_dwordx4 a[124:127], v3, s[16:19], s47 offen offset:3072 sc1
    s_waitcnt vmcnt(0)
    v_accvgpr_read_b32 v4, a124
    v_accvgpr_read_b32 v5, a125
    v_accvgpr_read_b32 v6, a126
    v_accvgpr_read_b32 v0, a127
    v_max3_u32 v203, v4, v5, v6
    v_max_u32 v203, v203, v0
    v_cmp_eq_u32 vcc, -1, v203
    s_nop 3
    s_cbranch_vccnz L_rt_h31
    s_branch L_ok_h31
L_rt_b0:
    s_add_u32 s39, s39, 1
    s_cmp_ge_u32 s39, 0x40000
    s_cbranch_scc1 L_ok_b0
    s_sleep 2
    s_add_u32 s69, s64, 0
    buffer_load_dwordx4 a[0:3], v15, s[16:19], s69 offen sc1
    buffer_load_dwordx4 a[4:7], v7, s[16:19], s69 offen sc1
    s_waitcnt vmcnt(0)
    v_accvgpr_read_b32 v4, a0
    v_accvgpr_read_b32 v5, a1
    v_accvgpr_read_b32 v6, a2
    v_accvgpr_read_b32 v0, a3
    v_max3_u32 v203, v4, v5, v6
    v_max_u32 v203, v203, v0
    v_accvgpr_read_b32 v4, a4
    v_accvgpr_read_b32 v5, a5
    v_accvgpr_read_b32 v6, a6
    v_accvgpr_read_b32 v0, a7
    v_max3_u32 v203, v203, v4, v5
    v_max3_u32 v203, v203, v6, v0
    v_cmp_eq_u32 vcc, -1, v203
    s_nop 3
    s_cbranch_vccnz L_rt_b0
    s_branch L_ok_b0
L_rt_b1:
    s_add_u32 s39, s39, 1
    s_cmp_ge_u32 s39, 0x40000
    s_cbranch_scc1 L_ok_b1
    s_sleep 2
    s_add_u32 s69, s65, 0
    buffer_load_dwordx4 a[8:11], v15, s[16:19], s69 offen sc1
    buffer_load_dwordx4 a[12:15], v7, s[16:19], s69 offen sc1
    s_waitcnt vmcnt(0)
    v_accvgpr_read_b32 v4, a8
    v_accvgpr_read_b32 v5, a9
    v_accvgpr_read_b32 v6, a10
    v_accvgpr_read_b32 v0, a11
    v_max3_u32 v203, v4, v5, v6
    v_max_u32 v203, v203, v0
    v_accvgpr_read_b32 v4, a12
    v_accvgpr_read_b32 v5, a13
    v_accvgpr_read_b32 v6, a14
    v_accvgpr_read_b32 v0, a15
    v_max3_u32 v203, v203, v4, v5
    v_max3_u32 v203, v203, v6, v0
    v_cmp_eq_u32 vcc, -1, v203
    s_nop 3
    s_cbranch_vccnz L_rt_b1
    s_branch L_ok_b1
L_rt_b2:
    s_add_u32 s39, s39, 1
    s_cmp_ge_u32 s39, 0x40000
    s_cbranch_scc1 L_ok_b2
    s_sleep 2
    s_add_u32 s69, s66, 0
    buffer_load_dwordx4 a[16:19], v15, s[16:19], s69 offen sc1
    buffer_load_dwordx4 a[20:23], v7, s[16:19], s69 offen sc1
    s_waitcnt vmcnt(0)
    v_accvgpr_read_b32 v4, a16
    v_accvgpr_read_b32 v5, a17
    v_accvgpr_read_b32 v6, a18
    v_accvgpr_read_b32 v0, a19
    v_max3_u32 v203, v4, v5, v6
    v_max_u32 v203, v203, v0
    v_accvgpr_read_b32 v4, a20
    v_accvgpr_read_b32 v5, a21
    v_accvgpr_read_b32 v6, a22
    v_accvgpr_read_b32 v0, a23
    v_max3_u32 v203, v203, v4, v5
    v_max3_u32 v203, v203, v6, v0
    v_cmp_eq_u32 vcc, -1, v203
    s_nop 3
    s_cbranch_vccnz L_rt_b2
    s_branch L_ok_b2
L_rt_b3:
    s_add_u32 s39, s39, 1
    s_cmp_ge_u32 s39, 0x40000
    s_cbranch_scc1 L_ok_b3
    s_sleep 2
    s_add_u32 s69, s67, 0
    buffer_load_dwordx4 a[24:27], v15, s[16:19], s69 offen sc1
    buffer_load_dwordx4 a[28:31], v7, s[16:19], s69 offen sc1
    s_waitcnt vmcnt(0)
    v_accvgpr_read_b32 v4, a24
    v_accvgpr_read_b32 v5, a25
    v_accvgpr_read_b32 v6, a26
    v_accvgpr_read_b32 v0, a27
    v_max3_u32 v203, v4, v5, v6
    v_max_u32 v203, v203, v0
    v_accvgpr_read_b32 v4, a28
    v_accvgpr_read_b32 v5, a29
    v_accvgpr_read_b32 v6, a30
    v_accvgpr_read_b32 v0, a31
    v_max3_u32 v203, v203, v4, v5
    v_max3_u32 v203, v203, v6, v0
    v_cmp_eq_u32 vcc, -1, v203
    s_nop 3
    s_cbranch_vccnz L_rt_b3
    s_branch L_ok_b3
L_rt_b4:
    s_add_u32 s39, s39, 1
    s_cmp_ge_u32 s39, 0x40000
    s_cbranch_scc1 L_ok_b4
    s_sleep 2
    s_add_u32 s69, s64, 1048576
    buffer_load_dwordx4 a[32:35], v15, s[16:19], s69 offen sc1
    buffer_load_dwordx4 a[36:39], v7, s[16:19], s69 offen sc1
    s_waitcnt vmcnt(0)
    v_accvgpr_read_b32 v4, a32
    v_accvgpr_read_b32 v5, a33
    v_accvgpr_read_b32 v6, a34
    v_accvgpr_read_b32 v0, a35
    v_max3_u32 v203, v4, v5, v6
    v_max_u32 v203, v203, v0
    v_accvgpr_read_b32 v4, a36
    v_accvgpr_read_b32 v5, a37
    v_accvgpr_read_b32 v6, a38
    v_accvgpr_read_b32 v0, a39
    v_max3_u32 v203, v203, v4, v5
    v_max3_u32 v203, v203, v6, v0
    v_cmp_eq_u32 vcc, -1, v203
    s_nop 3
    s_cbranch_vccnz L_rt_b4
    s_branch L_ok_b4
L_rt_b5:
    s_add_u32 s39, s39, 1
    s_cmp_ge_u32 s39, 0x40000
    s_cbranch_scc1 L_ok_b5
    s_sleep 2
    s_add_u32 s69, s65, 1048576
    buffer_load_dwordx4 a[40:43], v15, s[16:19], s69 offen sc1
    buffer_load_dwordx4 a[44:47], v7, s[16:19], s69 offen sc1
    s_waitcnt vmcnt(0)
    v_accvgpr_read_b32 v4, a40
    v_accvgpr_read_b32 v5, a41
    v_accvgpr_read_b32 v6, a42
    v_accvgpr_read_b32 v0, a43
    v_max3_u32 v203, v4, v5, v6
    v_max_u32 v203, v203, v0
    v_accvgpr_read_b32 v4, a44
    v_accvgpr_read_b32 v5, a45
    v_accvgpr_read_b32 v6, a46
    v_accvgpr_read_b32 v0, a47
    v_max3_u32 v203, v203, v4, v5
    v_max3_u32 v203, v203, v6, v0
    v_cmp_eq_u32 vcc, -1, v203
    s_nop 3
    s_cbranch_vccnz L_rt_b5
    s_branch L_ok_b5
L_rt_b6:
    s_add_u32 s39, s39, 1
    s_cmp_ge_u32 s39, 0x40000
    s_cbranch_scc1 L_ok_b6
    s_sleep 2
    s_add_u32 s69, s66, 1048576
    buffer_load_dwordx4 a[48:51], v15, s[16:19], s69 offen sc1
    buffer_load_dwordx4 a[52:55], v7, s[16:19], s69 offen sc1
    s_waitcnt vmcnt(0)
    v_accvgpr_read_b32 v4, a48
    v_accvgpr_read_b32 v5, a49
    v_accvgpr_read_b32 v6, a50
    v_accvgpr_read_b32 v0, a51
    v_max3_u32 v203, v4, v5, v6
    v_max_u32 v203, v203, v0
    v_accvgpr_read_b32 v4, a52
    v_accvgpr_read_b32 v5, a53
    v_accvgpr_read_b32 v6, a54
    v_accvgpr_read_b32 v0, a55
    v_max3_u32 v203, v203, v4, v5
    v_max3_u32 v203, v203, v6, v0
    v_cmp_eq_u32 vcc, -1, v203
    s_nop 3
    s_cbranch_vccnz L_rt_b6
    s_branch L_ok_b6
L_rt_b7:
    s_add_u32 s39, s39, 1
    s_cmp_ge_u32 s39, 0x40000
    s_cbranch_scc1 L_ok_b7
    s_sleep 2
    s_add_u32 s69, s67, 1048576
    buffer_load_dwordx4 a[56:59], v15, s[16:19], s69 offen sc1
    buffer_load_dwordx4 a[60:63], v7, s[16:19], s69 offen sc1
    s_waitcnt vmcnt(0)
    v_accvgpr_read_b32 v4, a56
    v_accvgpr_read_b32 v5, a57
    v_accvgpr_read_b32 v6, a58
    v_accvgpr_read_b32 v0, a59
    v_max3_u32 v203, v4, v5, v6
    v_max_u32 v203, v203, v0
    v_accvgpr_read_b32 v4, a60
    v_accvgpr_read_b32 v5, a61
    v_accvgpr_read_b32 v6, a62
    v_accvgpr_read_b32 v0, a63
    v_max3_u32 v203, v203, v4, v5
    v_max3_u32 v203, v203, v6, v0
    v_cmp_eq_u32 vcc, -1, v203
    s_nop 3
    s_cbranch_vccnz L_rt_b7
    s_branch L_ok_b7
L_rt_b8:
    s_add_u32 s39, s39, 1
    s_cmp_ge_u32 s39, 0x40000
    s_cbranch_scc1 L_ok_b8
    s_sleep 2
    s_add_u32 s69, s64, 2097152
    buffer_load_dwordx4 a[64:67], v15, s[16:19], s69 offen sc1
    buffer_load_dwordx4 a[68:71], v7, s[16:19], s69 offen sc1
    s_waitcnt vmcnt(0)
    v_accvgpr_read_b32 v4, a64
    v_accvgpr_read_b32 v5, a65
    v_accvgpr_read_b32 v6, a66
    v_accvgpr_read_b32 v0, a67
    v_max3_u32 v203, v4, v5, v6
    v_max_u32 v203, v203, v0
    v_accvgpr_read_b32 v4, a68
    v_accvgpr_read_b32 v5, a69
    v_accvgpr_read_b32 v6, a70
    v_accvgpr_read_b32 v0, a71
    v_max3_u32 v203, v203, v4, v5
    v_max3_u32 v203, v203, v6, v0
    v_cmp_eq_u32 vcc, -1, v203
    s_nop 3
    s_cbranch_vccnz L_rt_b8
    s_branch L_ok_b8
L_rt_b9:
    s_add_u32 s39, s39, 1
    s_cmp_ge_u32 s39, 0x40000
    s_cbranch_scc1 L_ok_b9
    s_sleep 2
    s_add_u32 s69, s65, 2097152
    buffer_load_dwordx4 a[72:75], v15, s[16:19], s69 offen sc1
    buffer_load_dwordx4 a[76:79], v7, s[16:19], s69 offen sc1
    s_waitcnt vmcnt(0)
    v_accvgpr_read_b32 v4, a72
    v_accvgpr_read_b32 v5, a73
    v_accvgpr_read_b32 v6, a74
    v_accvgpr_read_b32 v0, a75
    v_max3_u32 v203, v4, v5, v6
    v_max_u32 v203, v203, v0
    v_accvgpr_read_b32 v4, a76
    v_accvgpr_read_b32 v5, a77
    v_accvgpr_read_b32 v6, a78
    v_accvgpr_read_b32 v0, a79
    v_max3_u32 v203, v203, v4, v5
    v_max3_u32 v203, v203, v6, v0
    v_cmp_eq_u32 vcc, -1, v203
    s_nop 3
    s_cbranch_vccnz L_rt_b9
    s_branch L_ok_b9
L_rt_b10:
    s_add_u32 s39, s39, 1
    s_cmp_ge_u32 s39, 0x40000
    s_cbranch_scc1 L_ok_b10
    s_sleep 2
    s_add_u32 s69, s66, 2097152
    buffer_load_dwordx4 a[80:83], v15, s[16:19], s69 offen sc1
    buffer_load_dwordx4 a[84:87], v7, s[16:19], s69 offen sc1
    s_waitcnt vmcnt(0)
    v_accvgpr_read_b32 v4, a80
    v_accvgpr_read_b32 v5, a81
    v_accvgpr_read_b32 v6, a82
    v_accvgpr_read_b32 v0, a83
    v_max3_u32 v203, v4, v5, v6
    v_max_u32 v203, v203, v0
    v_accvgpr_read_b32 v4, a84
    v_accvgpr_read_b32 v5, a85
    v_accvgpr_read_b32 v6, a86
    v_accvgpr_read_b32 v0, a87
    v_max3_u32 v203, v203, v4, v5
    v_max3_u32 v203, v203, v6, v0
    v_cmp_eq_u32 vcc, -1, v203
    s_nop 3
    s_cbranch_vccnz L_rt_b10
    s_branch L_ok_b10
L_rt_b11:
    s_add_u32 s39, s39, 1
    s_cmp_ge_u32 s39, 0x40000
    s_cbranch_scc1 L_ok_b11
    s_sleep 2
    s_add_u32 s69, s67, 2097152
    buffer_load_dwordx4 a[88:91], v15, s[16:19], s69 offen sc1
    buffer_load_dwordx4 a[92:95], v7, s[16:19], s69 offen sc1
    s_waitcnt vmcnt(0)
    v_accvgpr_read_b32 v4, a88
    v_accvgpr_read_b32 v5, a89
    v_accvgpr_read_b32 v6, a90
    v_accvgpr_read_b32 v0, a91
    v_max3_u32 v203, v4, v5, v6
    v_max_u32 v203, v203, v0
    v_accvgpr_read_b32 v4, a92
    v_accvgpr_read_b32 v5, a93
    v_accvgpr_read_b32 v6, a94
    v_accvgpr_read_b32 v0, a95
    v_max3_u32 v203, v203, v4, v5
    v_max3_u32 v203, v203, v6, v0
    v_cmp_eq_u32 vcc, -1, v203
    s_nop 3
    s_cbranch_vccnz L_rt_b11
    s_branch L_ok_b11
L_rt_b12:
    s_add_u32 s39, s39, 1
    s_cmp_ge_u32 s39, 0x40000
    s_cbranch_scc1 L_ok_b12
    s_sleep 2
    s_add_u32 s69, s64, 3145728
    buffer_load_dwordx4 a[96:99], v15, s[16:19], s69 offen sc1
    buffer_load_dwordx4 a[100:103], v7, s[16:19], s69 offen sc1
    s_waitcnt vmcnt(0)
    v_accvgpr_read_b32 v4, a96
    v_accvgpr_read_b32 v5, a97
    v_accvgpr_read_b32 v6, a98
    v_accvgpr_read_b32 v0, a99
    v_max3_u32 v203, v4, v5, v6
    v_max_u32 v203, v203, v0
    v_accvgpr_read_b32 v4, a100
    v_accvgpr_read_b32 v5, a101
    v_accvgpr_read_b32 v6, a102
    v_accvgpr_read_b32 v0, a103
    v_max3_u32 v203, v203, v4, v5
    v_max3_u32 v203, v203, v6, v0
    v_cmp_eq_u32 vcc, -1, v203
    s_nop 3
    s_cbranch_vccnz L_rt_b12
    s_branch L_ok_b12
L_rt_b13:
    s_add_u32 s39, s39, 1
    s_cmp_ge_u32 s39, 0x40000
    s_cbranch_scc1 L_ok_b13
    s_sleep 2
    s_add_u32 s69, s65, 3145728
    buffer_load_dwordx4 a[104:107], v15, s[16:19], s69 offen sc1
    buffer_load_dwordx4 a[108:111], v7, s[16:19], s69 offen sc1
    s_waitcnt vmcnt(0)
    v_accvgpr_read_b32 v4, a104
    v_accvgpr_read_b32 v5, a105
    v_accvgpr_read_b32 v6, a106
    v_accvgpr_read_b32 v0, a107
    v_max3_u32 v203, v4, v5, v6
    v_max_u32 v203, v203, v0
    v_accvgpr_read_b32 v4, a108
    v_accvgpr_read_b32 v5, a109
    v_accvgpr_read_b32 v6, a110
    v_accvgpr_read_b32 v0, a111
    v_max3_u32 v203, v203, v4, v5
    v_max3_u32 v203, v203, v6, v0
    v_cmp_eq_u32 vcc, -1, v203
    s_nop 3
    s_cbranch_vccnz L_rt_b13
    s_branch L_ok_b13
L_rt_b14:
    s_add_u32 s39, s39, 1
    s_cmp_ge_u32 s39, 0x40000
    s_cbranch_scc1 L_ok_b14
    s_sleep 2
    s_add_u32 s69, s66, 3145728
    buffer_load_dwordx4 a[112:115], v15, s[16:19], s69 offen sc1
    buffer_load_dwordx4 a[116:119], v7, s[16:19], s69 offen sc1
    s_waitcnt vmcnt(0)
    v_accvgpr_read_b32 v4, a112
    v_accvgpr_read_b32 v5, a113
    v_accvgpr_read_b32 v6, a114
    v_accvgpr_read_b32 v0, a115
    v_max3_u32 v203, v4, v5, v6
    v_max_u32 v203, v203, v0
    v_accvgpr_read_b32 v4, a116
    v_accvgpr_read_b32 v5, a117
    v_accvgpr_read_b32 v6, a118
    v_accvgpr_read_b32 v0, a119
    v_max3_u32 v203, v203, v4, v5
    v_max3_u32 v203, v203, v6, v0
    v_cmp_eq_u32 vcc, -1, v203
    s_nop 3
    s_cbranch_vccnz L_rt_b14
    s_branch L_ok_b14
L_rt_b15:
    s_add_u32 s39, s39, 1
    s_cmp_ge_u32 s39, 0x40000
    s_cbranch_scc1 L_ok_b15
    s_sleep 2
    s_add_u32 s69, s67, 3145728
    buffer_load_dwordx4 a[120:123], v15, s[16:19], s69 offen sc1
    buffer_load_dwordx4 a[124:127], v7, s[16:19], s69 offen sc1
    s_waitcnt vmcnt(0)
    v_accvgpr_read_b32 v4, a120
    v_accvgpr_read_b32 v5, a121
    v_accvgpr_read_b32 v6, a122
    v_accvgpr_read_b32 v0, a123
    v_max3_u32 v203, v4, v5, v6
    v_max_u32 v203, v203, v0
    v_accvgpr_read_b32 v4, a124
    v_accvgpr_read_b32 v5, a125
    v_accvgpr_read_b32 v6, a126
    v_accvgpr_read_b32 v0, a127
    v_max3_u32 v203, v203, v4, v5
    v_max3_u32 v203, v203, v6, v0
    v_cmp_eq_u32 vcc, -1, v203
    s_nop 3
    s_cbranch_vccnz L_rt_b15
    s_branch L_ok_b15
L_rt_b16:
    s_add_u32 s39, s39, 1
    s_cmp_ge_u32 s39, 0x40000
    s_cbranch_scc1 L_ok_b16
    s_sleep 2
    s_add_u32 s69, s64, 4194304
    buffer_load_dwordx4 v[80:83], v15, s[16:19], s69 offen sc1
    buffer_load_dwordx4 v[84:87], v7, s[16:19], s69 offen sc1
    s_waitcnt vmcnt(0)
    v_max3_u32 v203, v80, v81, v82
    v_max_u32 v203, v203, v83
    v_max3_u32 v203, v203, v84, v85
    v_max3_u32 v203, v203, v86, v87
    v_cmp_eq_u32 vcc, -1, v203
    s_nop 3
    s_cbranch_vccnz L_rt_b16
    s_branch L_ok_b16
L_rt_b17:
    s_add_u32 s39, s39, 1
    s_cmp_ge_u32 s39, 0x40000
    s_cbranch_scc1 L_ok_b17
    s_sleep 2
    s_add_u32 s69, s65, 4194304
    buffer_load_dwordx4 v[88:91], v15, s[16:19], s69 offen sc1
    buffer_load_dwordx4 v[92:95], v7, s[16:19], s69 offen sc1
    s_waitcnt vmcnt(0)
    v_max3_u32 v203, v88, v89, v90
    v_max_u32 v203, v203, v91
    v_max3_u32 v203, v203, v92, v93
    v_max3_u32 v203, v203, v94, v95
    v_cmp_eq_u32 vcc, -1, v203
    s_nop 3
    s_cbranch_vccnz L_rt_b17
    s_branch L_ok_b17
L_rt_b18:
    s_add_u32 s39, s39, 1
    s_cmp_ge_u32 s39, 0x40000
    s_cbranch_scc1 L_ok_b18
    s_sleep 2
    s_add_u32 s69, s66, 4194304
    buffer_load_dwordx4 v[96:99], v15, s[16:19], s69 offen sc1
    buffer_load_dwordx4 v[100:103], v7, s[16:19], s69 offen sc1
    s_waitcnt vmcnt(0)
    v_max3_u32 v203, v96, v97, v98
    v_max_u32 v203, v203, v99
    v_max3_u32 v203, v203, v100, v101
    v_max3_u32 v203, v203, v102, v103
    v_cmp_eq_u32 vcc, -1, v203
    s_nop 3
    s_cbranch_vccnz L_rt_b18
    s_branch L_ok_b18
L_rt_b19:
    s_add_u32 s39, s39, 1
    s_cmp_ge_u32 s39, 0x40000
    s_cbranch_scc1 L_ok_b19
    s_sleep 2
    s_add_u32 s69, s67, 4194304
    buffer_load_dwordx4 v[104:107], v15, s[16:19], s69 offen sc1
    buffer_load_dwordx4 v[108:111], v7, s[16:19], s69 offen sc1
    s_waitcnt vmcnt(0)
    v_max3_u32 v203, v104, v105, v106
    v_max_u32 v203, v203, v107
    v_max3_u32 v203, v203, v108, v109
    v_max3_u32 v203, v203, v110, v111
    v_cmp_eq_u32 vcc, -1, v203
    s_nop 3
    s_cbranch_vccnz L_rt_b19
    s_branch L_ok_b19
L_rt_b20:
    s_add_u32 s39, s39, 1
    s_cmp_ge_u32 s39, 0x40000
    s_cbranch_scc1 L_ok_b20
    s_sleep 2
    s_add_u32 s69, s64, 5242880
    buffer_load_dwordx4 v[112:115], v15, s[16:19], s69 offen sc1
    buffer_load_dwordx4 v[116:119], v7, s[16:19], s69 offen sc1
    s_waitcnt vmcnt(0)
    v_max3_u32 v203, v112, v113, v114
    v_max_u32 v203, v203, v115
    v_max3_u32 v203, v203, v116, v117
    v_max3_u32 v203, v203, v118, v119
    v_cmp_eq_u32 vcc, -1, v203
    s_nop 3
    s_cbranch_vccnz L_rt_b20
    s_branch L_ok_b20
L_rt_b21:
    s_add_u32 s39, s39, 1
    s_cmp_ge_u32 s39, 0x40000
    s_cbranch_scc1 L_ok_b21
    s_sleep 2
    s_add_u32 s69, s65, 5242880
    buffer_load_dwordx4 v[120:123], v15, s[16:19], s69 offen sc1
    buffer_load_dwordx4 v[124:127], v7, s[16:19], s69 offen sc1
    s_waitcnt vmcnt(0)
    v_max3_u32 v203, v120, v121, v122
    v_max_u32 v203, v203, v123
    v_max3_u32 v203, v203, v124, v125
    v_max3_u32 v203, v203, v126, v127
    v_cmp_eq_u32 vcc, -1, v203
    s_nop 3
    s_cbranch_vccnz L_rt_b21
    s_branch L_ok_b21
L_rt_b22:
    s_add_u32 s39, s39, 1
    s_cmp_ge_u32 s39, 0x40000
    s_cbranch_scc1 L_ok_b22
    s_sleep 2
    s_add_u32 s69, s66, 5242880
    buffer_load_dwordx4 a[0:3], v15, s[16:19], s69 offen sc1
    buffer_load_dwordx4 a[4:7], v7, s[16:19], s69 offen sc1
    s_waitcnt vmcnt(0)
    v_accvgpr_read_b32 v4, a0
    v_accvgpr_read_b32 v5, a1
    v_accvgpr_read_b32 v6, a2
    v_accvgpr_read_b32 v0, a3
    v_max3_u32 v203, v4, v5, v6
    v_max_u32 v203, v203, v0
    v_accvgpr_read_b32 v4, a4
    v_accvgpr_read_b32 v5, a5
    v_accvgpr_read_b32 v6, a6
    v_accvgpr_read_b32 v0, a7
    v_max3_u32 v203, v203, v4, v5
    v_max3_u32 v203, v203, v6, v0
    v_cmp_eq_u32 vcc, -1, v203
    s_nop 3
    s_cbranch_vccnz L_rt_b22
    s_branch L_ok_b22
L_rt_b23:
    s_add_u32 s39, s39, 1
    s_cmp_ge_u32 s39, 0x40000
    s_cbranch_scc1 L_ok_b23
    s_sleep 2
    s_add_u32 s69, s67, 5242880
    buffer_load_dwordx4 a[8:11], v15, s[16:19], s69 offen sc1
    buffer_load_dwordx4 a[12:15], v7, s[16:19], s69 offen sc1
    s_waitcnt vmcnt(0)
    v_accvgpr_read_b32 v4, a8
    v_accvgpr_read_b32 v5, a9
    v_accvgpr_read_b32 v6, a10
    v_accvgpr_read_b32 v0, a11
    v_max3_u32 v203, v4, v5, v6
    v_max_u32 v203, v203, v0
    v_accvgpr_read_b32 v4, a12
    v_accvgpr_read_b32 v5, a13
    v_accvgpr_read_b32 v6, a14
    v_accvgpr_read_b32 v0, a15
    v_max3_u32 v203, v203, v4, v5
    v_max3_u32 v203, v203, v6, v0
    v_cmp_eq_u32 vcc, -1, v203
    s_nop 3
    s_cbranch_vccnz L_rt_b23
    s_branch L_ok_b23
L_rt_b24:
    s_add_u32 s39, s39, 1
    s_cmp_ge_u32 s39, 0x40000
    s_cbranch_scc1 L_ok_b24
    s_sleep 2
    s_add_u32 s69, s64, 6291456
    buffer_load_dwordx4 a[16:19], v15, s[16:19], s69 offen sc1
    buffer_load_dwordx4 a[20:23], v7, s[16:19], s69 offen sc1
    s_waitcnt vmcnt(0)
    v_accvgpr_read_b32 v4, a16
    v_accvgpr_read_b32 v5, a17
    v_accvgpr_read_b32 v6, a18
    v_accvgpr_read_b32 v0, a19
    v_max3_u32 v203, v4, v5, v6
    v_max_u32 v203, v203, v0
    v_accvgpr_read_b32 v4, a20
    v_accvgpr_read_b32 v5, a21
    v_accvgpr_read_b32 v6, a22
    v_accvgpr_read_b32 v0, a23
    v_max3_u32 v203, v203, v4, v5
    v_max3_u32 v203, v203, v6, v0
    v_cmp_eq_u32 vcc, -1, v203
    s_nop 3
    s_cbranch_vccnz L_rt_b24
    s_branch L_ok_b24
L_rt_b25:
    s_add_u32 s39, s39, 1
    s_cmp_ge_u32 s39, 0x40000
    s_cbranch_scc1 L_ok_b25
    s_sleep 2
    s_add_u32 s69, s65, 6291456
    buffer_load_dwordx4 a[24:27], v15, s[16:19], s69 offen sc1
    buffer_load_dwordx4 a[28:31], v7, s[16:19], s69 offen sc1
    s_waitcnt vmcnt(0)
    v_accvgpr_read_b32 v4, a24
    v_accvgpr_read_b32 v5, a25
    v_accvgpr_read_b32 v6, a26
    v_accvgpr_read_b32 v0, a27
    v_max3_u32 v203, v4, v5, v6
    v_max_u32 v203, v203, v0
    v_accvgpr_read_b32 v4, a28
    v_accvgpr_read_b32 v5, a29
    v_accvgpr_read_b32 v6, a30
    v_accvgpr_read_b32 v0, a31
    v_max3_u32 v203, v203, v4, v5
    v_max3_u32 v203, v203, v6, v0
    v_cmp_eq_u32 vcc, -1, v203
    s_nop 3
    s_cbranch_vccnz L_rt_b25
    s_branch L_ok_b25
L_rt_b26:
    s_add_u32 s39, s39, 1
    s_cmp_ge_u32 s39, 0x40000
    s_cbranch_scc1 L_ok_b26
    s_sleep 2
    s_add_u32 s69, s66, 6291456
    buffer_load_dwordx4 a[32:35], v15, s[16:19], s69 offen sc1
    buffer_load_dwordx4 a[36:39], v7, s[16:19], s69 offen sc1
    s_waitcnt vmcnt(0)
    v_accvgpr_read_b32 v4, a32
    v_accvgpr_read_b32 v5, a33
    v_accvgpr_read_b32 v6, a34
    v_accvgpr_read_b32 v0, a35
    v_max3_u32 v203, v4, v5, v6
    v_max_u32 v203, v203, v0
    v_accvgpr_read_b32 v4, a36
    v_accvgpr_read_b32 v5, a37
    v_accvgpr_read_b32 v6, a38
    v_accvgpr_read_b32 v0, a39
    v_max3_u32 v203, v203, v4, v5
    v_max3_u32 v203, v203, v6, v0
    v_cmp_eq_u32 vcc, -1, v203
    s_nop 3
    s_cbranch_vccnz L_rt_b26
    s_branch L_ok_b26
L_rt_b27:
    s_add_u32 s39, s39, 1
    s_cmp_ge_u32 s39, 0x40000
    s_cbranch_scc1 L_ok_b27
    s_sleep 2
    s_add_u32 s69, s67, 6291456
    buffer_load_dwordx4 a[40:43], v15, s[16:19], s69 offen sc1
    buffer_load_dwordx4 a[44:47], v7, s[16:19], s69 offen sc1
    s_waitcnt vmcnt(0)
    v_accvgpr_read_b32 v4, a40
    v_accvgpr_read_b32 v5, a41
    v_accvgpr_read_b32 v6, a42
    v_accvgpr_read_b32 v0, a43
    v_max3_u32 v203, v4, v5, v6
    v_max_u32 v203, v203, v0
    v_accvgpr_read_b32 v4, a44
    v_accvgpr_read_b32 v5, a45
    v_accvgpr_read_b32 v6, a46
    v_accvgpr_read_b32 v0, a47
    v_max3_u32 v203, v203, v4, v5
    v_max3_u32 v203, v203, v6, v0
    v_cmp_eq_u32 vcc, -1, v203
    s_nop 3
    s_cbranch_vccnz L_rt_b27
    s_branch L_ok_b27
L_code_end:
    s_endpgm
.section .rodata,"a"
.p2align 6
.amdhsa_kernel k1_qkv_kernel
  .amdhsa_next_free_vgpr 220
  .amdhsa_next_free_sgpr 102
  .amdhsa_accum_offset 220
  .amdhsa_group_segment_fixed_size 0
  .amdhsa_kernarg_size 80
  .amdhsa_user_sgpr_count 2
  .amdhsa_user_sgpr_kernarg_segment_ptr 1
  .amdhsa_system_sgpr_workgroup_id_x 1
.end_amdhsa_kernel
.p2align 6
.amdhsa_kernel k2_attn_kernel
  .amdhsa_next_free_vgpr 128
  .amdhsa_next_free_sgpr 102
  .amdhsa_accum_offset 128
  .amdhsa_group_segment_fixed_size 0
  .amdhsa_kernarg_size 80
  .amdhsa_user_sgpr_count 2
  .amdhsa_user_sgpr_kernarg_segment_ptr 1
  .amdhsa_system_sgpr_workgroup_id_x 1
.end_amdhsa_kernel
.p2align 6
.amdhsa_kernel k4_ffn_kernel
  .amdhsa_next_free_vgpr 512
  .amdhsa_next_free_sgpr 102
  .amdhsa_accum_offset 256
  .amdhsa_group_segment_fixed_size 0
  .amdhsa_kernarg_size 80
  .amdhsa_user_sgpr_count 2
  .amdhsa_user_sgpr_kernarg_segment_ptr 1
  .amdhsa_system_sgpr_workgroup_id_x 1
.end_amdhsa_kernel
```
